```python
import torch

def _softmax(x, axis=-1):
    return torch.softmax(x, dim=axis)
def _gelu(x):
    return torch.nn.functional.gelu(x, approximate="tanh")
def _silu(x):
    return torch.nn.functional.silu(x)
def _sigmoid(x):
    return torch.sigmoid(x)
def _layernorm(x, axis=-1, eps=1e-5):
    m = x.mean(dim=axis, keepdim=True)
    v = x.var(dim=axis, keepdim=True, unbiased=False)
    return (x - m) / torch.sqrt(v + eps)
def _scatter_add(tgt, idx, src, axis=0):
    return tgt.clone().index_add_(axis, idx, src)
def _segment_sum(src, seg, n):
    out = torch.zeros((n,) + src.shape[1:], dtype=src.dtype)
    return out.index_add_(0, seg, src)
def _pad(x, pw):
    flat = tuple(v for pair in reversed(pw) for v in pair)
    return torch.nn.functional.pad(x, flat)

kernel_name = 'gated_mix__mha_block_cached__sliding_block_cached__decode'

def setup_inputs():

    _w = (lambda a: (lambda t: t.to(torch.bfloat16) if t.is_floating_point() else t)(torch.as_tensor(a)))
    def _A_setup():
        B, Sq, D = 4, 1, 512
        H, Sk, Dh = 32, 4096, 128
        return {
            "x": _w((lambda *s: torch.randn(*s, dtype=torch.bfloat16) * 0.05)(B, Sq, D)),
            "k_cache": _w((lambda *s: torch.randn(*s, dtype=torch.bfloat16) * 6.4)(B, H, Sk, Dh)),
            "v_cache": _w((lambda *s: torch.randn(*s, dtype=torch.bfloat16) * 0.05)(B, H, Sk, Dh)),
            "wq": _w((lambda *s: torch.randn(*s, dtype=torch.bfloat16) * 6.4)(D, H * Dh) * (D ** -0.5)),
            "wo": _w((lambda *s: torch.randn(*s, dtype=torch.bfloat16) * 0.05)(H * Dh, D) * ((H * Dh) ** -0.5)),
        }
    _A_in = _A_setup()

    def _B_setup():
        B, Sq, D = 4, 1, 512
        Hq, Hkv, Sk, Dh = 32, 32, 4096, 128
        assert Hq % Hkv == 0, (Hq, Hkv)
        return {
            "x": _w((lambda *s: torch.randn(*s, dtype=torch.bfloat16) * 0.05)(B, Sq, D)),
            "k_cache": _w((lambda *s: torch.randn(*s, dtype=torch.bfloat16) * 6.4)(B, Hkv, Sk, Dh)),
            "v_cache": _w((lambda *s: torch.randn(*s, dtype=torch.bfloat16) * 0.05)(B, Hkv, Sk, Dh)),
            "wq": _w((lambda *s: torch.randn(*s, dtype=torch.bfloat16) * 6.4)(D, Hq * Dh) * (D ** -0.5)),
            "wo": _w((lambda *s: torch.randn(*s, dtype=torch.bfloat16) * 0.05)(Hq * Dh, D) * ((Hq * Dh) ** -0.5)),
        }
    _B_in = _B_setup()

    return {
        "A_x": _A_in["x"],
        "A_k_cache": _A_in["k_cache"],
        "A_v_cache": _A_in["v_cache"],
        "A_wq": _A_in["wq"],
        "A_wo": _A_in["wo"],
        "B_x": _B_in["x"],
        "B_k_cache": _B_in["k_cache"],
        "B_v_cache": _B_in["v_cache"],
        "B_wq": _B_in["wq"],
        "B_wo": _B_in["wo"],
        "gate_w": _w((lambda *s: torch.randn(*s, dtype=torch.bfloat16) * 0.1)(512) * 16.0),
    }

def reference(A_x, A_k_cache, A_v_cache, A_wq, A_wo, B_x, B_k_cache, B_v_cache, B_wq, B_wo, gate_w):
    def _A_ref(x, k_cache, v_cache, wq, wo):
        B, Sq, D = x.shape
        H, Dh = 32, 128
        q = (lambda x, *d: x.permute(*d))((x @ wq).reshape(B, Sq, H, Dh), 0, 2, 1, 3)
        scores = torch.einsum("bhqd,bhkd->bhqk", q, k_cache) * (Dh ** -0.5)
        p = _softmax(scores, axis=-1)
        o = torch.einsum("bhqk,bhkd->bhqd", p, v_cache)
        return (lambda x, *d: x.permute(*d))(o, 0, 2, 1, 3).reshape(B, Sq, H * Dh) @ wo

    def _B_ref(x, k_cache, v_cache, wq, wo):
        B, Sq, D = x.shape
        Hq, Dh = 32, 128
        Hkv, Sk = k_cache.shape[1], k_cache.shape[2]
        W = min(4096, max(256, Sk // 4))
        rep = Hq // Hkv
        q = (lambda x, *d: x.permute(*d))((x @ wq).reshape(B, Sq, Hq, Dh), 0, 2, 1, 3)
        k = (lambda x, n, axis: torch.repeat_interleave(x, n, dim=axis))(k_cache[:, :, Sk - W:, :], rep, axis=1)
        v = (lambda x, n, axis: torch.repeat_interleave(x, n, dim=axis))(v_cache[:, :, Sk - W:, :], rep, axis=1)
        scores = torch.einsum("bhqd,bhkd->bhqk", q, k) * (Dh ** -0.5)
        p = _softmax(scores, axis=-1)
        o = torch.einsum("bhqk,bhkd->bhqd", p, v)
        return (lambda x, *d: x.permute(*d))(o, 0, 2, 1, 3).reshape(B, Sq, Hq * Dh) @ wo

    x = A_x
    g = _sigmoid((x * gate_w).sum(-1, keepdims=True))
    a = _A_ref(x, A_k_cache, A_v_cache, A_wq, A_wo)
    b = _B_ref(x, B_k_cache, B_v_cache, B_wq, B_wo)
    return g * a + (1 - g) * b
```

```asm
; @launch grid=(256,1,1) block=(512,1,1) lds=157504
.amdgcn_target "amdgcn-amd-amdhsa--gfx950"
.text
.globl gated_mix__mha_block_cached__sliding_block_cached__decode_kernel
.p2align 8
.type gated_mix__mha_block_cached__sliding_block_cached__decode_kernel,@function
gated_mix__mha_block_cached__sliding_block_cached__decode_kernel:
  s_cmp_ge_u32 s2, 256
  s_cbranch_scc1 L_end
  s_load_dwordx8 s[8:15], s[0:1], 0
  s_load_dwordx2 s[16:17], s[0:1], 32
  s_load_dwordx8 s[20:27], s[0:1], 48
  s_load_dwordx4 s[4:7], s[0:1], 80
  s_load_dwordx4 s[28:31], s[0:1], 96
  v_lshrrev_b32 v14, 6, v0
  v_and_b32 v1, 63, v0
  v_readfirstlane_b32 s3, v14
  v_and_b32 v10, 15, v1
  v_lshrrev_b32 v11, 4, v1
  v_bfe_u32 v14, v1, 2, 2
  v_lshlrev_b32 v2, 8, v14
  v_lshl_add_u32 v2, v11, 6, v2
  v_and_b32 v14, 3, v1
  v_lshl_add_u32 v2, v14, 4, v2
  v_lshlrev_b32 v3, 4, v1
  v_lshlrev_b32 v4, 13, v11
  v_lshl_add_u32 v4, v10, 4, v4
  v_lshrrev_b32 v14, 3, v10
  v_lshl_add_u32 v14, v14, 2, v11
  v_lshlrev_b32 v5, 10, v14
  v_and_b32 v14, 7, v10
  v_lshl_add_u32 v5, v14, 4, v5
  s_and_b32 s60, s2, 7
  s_lshl_b32 s60, s60, 2
  s_bfe_u32 s64, s2, 0x20003
  s_add_u32 s60, s60, s64
  s_bfe_u32 s61, s2, 0x20005
  s_lshr_b32 s62, s2, 7
  s_lshl_b32 s63, s61, 5
  s_add_u32 s63, s63, s60
  s_lshl_b32 s64, s63, 20
  s_lshl_b32 s65, s3, 13
  s_add_u32 s64, s64, s65
  s_add_u32 s64, s64, 4096
  s_mul_i32 s65, s62, 655360
  s_add_u32 s65, s65, s64
  s_add_u32 s66, s64, 786432
  s_lshl_b32 s67, s61, 8
  s_lshl_b32 s64, s3, 5
  s_add_u32 s67, s67, s64
  v_lshrrev_b32 v14, 3, v10
  v_lshlrev_b32 v14, 10, v14
  v_lshl_add_u32 v14, v11, 1, v14
  v_add_u32 v14, s67, v14
  s_waitcnt lgkmcnt(0)
  s_or_b32 s92, s61, s62
  s_or_b32 s92, s92, s3
  s_cmp_lg_u32 s92, 0
  s_cbranch_scc1 L_tag1
  s_memrealtime s[92:93]
  s_waitcnt lgkmcnt(0)
  s_or_b32 s92, s92, 1
  s_lshl_b32 s93, s60, 2
  v_mov_b32 v32, s93
  v_mov_b32 v33, s92
  s_mov_b64 exec, 1
  global_store_dword v32, v33, s[28:29] sc1
  s_mov_b64 exec, -1
L_tag1:
  global_load_ushort v108, v14, s[8:9] offset:0
  global_load_ushort v109, v14, s[8:9] offset:8
  global_load_ushort v110, v14, s[8:9] offset:16
  global_load_ushort v111, v14, s[8:9] offset:24
  global_load_ushort v112, v14, s[8:9] offset:2048
  global_load_ushort v113, v14, s[8:9] offset:2056
  global_load_ushort v114, v14, s[8:9] offset:2064
  global_load_ushort v115, v14, s[8:9] offset:2072
  s_cmp_eq_u32 s62, 0
  s_cselect_b32 s40, s14, s24
  s_cselect_b32 s41, s15, s25
  s_cselect_b32 s42, s16, s26
  s_cselect_b32 s43, s17, s27
  s_lshl_b32 s64, s67, 12
  s_lshl_b32 s67, s60, 8
  s_add_u32 s64, s64, s67
  s_add_u32 s40, s40, s64
  s_addc_u32 s41, s41, 0
  global_load_dwordx4 v[76:79], v4, s[40:41] nt
  s_add_u32 s40, s40, 0x8000
  s_addc_u32 s41, s41, 0
  global_load_dwordx4 v[80:83], v4, s[40:41] nt
  s_add_u32 s40, s40, 0x8000
  s_addc_u32 s41, s41, 0
  global_load_dwordx4 v[84:87], v4, s[40:41] nt
  s_add_u32 s40, s40, 0x8000
  s_addc_u32 s41, s41, 0
  global_load_dwordx4 v[88:91], v4, s[40:41] nt
  s_add_u32 s32, s10, s65
  s_addc_u32 s33, s11, 0
  s_add_u32 s34, s12, s65
  s_addc_u32 s35, s13, 0
  s_add_u32 s36, s20, s66
  s_addc_u32 s37, s21, 0
  s_add_u32 s38, s22, s66
  s_addc_u32 s39, s23, 0
  s_lshl_b32 s64, s60, 17
  s_lshl_b32 s65, s3, 7
  s_add_u32 s64, s64, s65
  s_add_u32 s42, s42, s64
  s_addc_u32 s43, s43, 0
  global_load_dwordx4 v[124:127], v2, s[32:33] offset:-4096 nt
  global_load_dwordx4 v[128:131], v2, s[32:33] offset:-3072 nt
  v_mov_b32 v12, 0x3fb8aa3b
  v_mov_b32 v13, 0x3db504f3
  v_and_b32 v14, 1, v10
  v_lshlrev_b32 v14, 4, v14
  v_mov_b32 v32, 0xffff
  v_lshlrev_b32 v32, v14, v32
  v_bfe_u32 v14, v10, 1, 2
  v_cmp_eq_u32 vcc, 0, v14
  s_nop 1
  v_cndmask_b32 v6, 0, v32, vcc
  v_cmp_eq_u32 vcc, 1, v14
  s_nop 1
  v_cndmask_b32 v7, 0, v32, vcc
  v_cmp_eq_u32 vcc, 2, v14
  s_nop 1
  v_cndmask_b32 v8, 0, v32, vcc
  v_cmp_eq_u32 vcc, 3, v14
  s_nop 1
  v_cndmask_b32 v9, 0, v32, vcc
  s_mov_b32 s44, 0x22222222
  s_mov_b32 s45, 0x22222222
  s_mov_b32 s46, 0x44444444
  s_mov_b32 s47, 0x44444444
  s_mov_b32 s48, 0x88888888
  s_mov_b32 s49, 0x88888888
  s_mov_b32 s50, 0xf000f
  s_mov_b32 s51, 0xf000f
  s_mov_b32 s52, 0xf000f0
  s_mov_b32 s53, 0xf000f0
  s_mov_b32 s54, 0xf000f00
  s_mov_b32 s55, 0xf000f00
  s_mov_b32 s56, 0xf000f000
  s_mov_b32 s57, 0xf000f000
  s_mov_b32 s58, 0xff00ff00
  s_mov_b32 s59, 0xff00ff00
  s_waitcnt vmcnt(2)
  v_lshl_or_b32 v108, v108, 16, v108
  v_lshl_or_b32 v109, v109, 16, v109
  v_lshl_or_b32 v110, v110, 16, v110
  v_lshl_or_b32 v111, v111, 16, v111
  v_lshl_or_b32 v112, v112, 16, v112
  v_lshl_or_b32 v113, v113, 16, v113
  v_lshl_or_b32 v114, v114, 16, v114
  v_lshl_or_b32 v115, v115, 16, v115
  v_and_b32 v60, v108, v6
  v_and_b32 v61, v108, v7
  v_and_b32 v62, v108, v8
  v_and_b32 v63, v108, v9
  s_nop 1
  v_mfma_f32_16x16x32_bf16 v[68:71], v[60:63], v[76:79], 0
  v_and_b32 v64, v109, v6
  v_and_b32 v65, v109, v7
  v_and_b32 v66, v109, v8
  v_and_b32 v67, v109, v9
  s_nop 1
  v_mfma_f32_16x16x32_bf16 v[68:71], v[64:67], v[80:83], v[68:71]
  v_and_b32 v60, v110, v6
  v_and_b32 v61, v110, v7
  v_and_b32 v62, v110, v8
  v_and_b32 v63, v110, v9
  s_nop 1
  v_mfma_f32_16x16x32_bf16 v[68:71], v[60:63], v[84:87], v[68:71]
  v_and_b32 v64, v111, v6
  v_and_b32 v65, v111, v7
  v_and_b32 v66, v111, v8
  v_and_b32 v67, v111, v9
  s_nop 1
  v_mfma_f32_16x16x32_bf16 v[68:71], v[64:67], v[88:91], v[68:71]
  v_and_b32 v60, v112, v6
  v_and_b32 v61, v112, v7
  v_and_b32 v62, v112, v8
  v_and_b32 v63, v112, v9
  s_nop 1
  v_mfma_f32_16x16x32_bf16 v[72:75], v[60:63], v[76:79], 0
  v_and_b32 v64, v113, v6
  v_and_b32 v65, v113, v7
  v_and_b32 v66, v113, v8
  v_and_b32 v67, v113, v9
  s_nop 1
  v_mfma_f32_16x16x32_bf16 v[72:75], v[64:67], v[80:83], v[72:75]
  v_and_b32 v60, v114, v6
  v_and_b32 v61, v114, v7
  v_and_b32 v62, v114, v8
  v_and_b32 v63, v114, v9
  s_nop 1
  v_mfma_f32_16x16x32_bf16 v[72:75], v[60:63], v[84:87], v[72:75]
  v_and_b32 v64, v115, v6
  v_and_b32 v65, v115, v7
  v_and_b32 v66, v115, v8
  v_and_b32 v67, v115, v9
  s_nop 1
  v_mfma_f32_16x16x32_bf16 v[72:75], v[64:67], v[88:91], v[72:75]
  v_lshrrev_b32 v14, 1, v11
  v_lshlrev_b32 v14, 9, v14
  v_lshl_add_u32 v14, v10, 5, v14
  v_and_b32 v32, 1, v11
  v_lshl_add_u32 v14, v32, 4, v14
  s_lshl_b32 s64, s3, 11
  s_add_u32 s64, s64, 131072
  v_add_u32 v14, s64, v14
  s_nop 4
  ds_write_b128 v14, v[68:71]
  ds_write_b128 v14, v[72:75] offset:1024
  s_waitcnt lgkmcnt(0)
  s_barrier
  s_cmp_lg_u32 s3, 0
  s_cbranch_scc1 L_pf3
  v_add_u32 v14, 131072, v3
  ds_read_b128 v[76:79], v14 offset:0
  ds_read_b128 v[80:83], v14 offset:2048
  ds_read_b128 v[84:87], v14 offset:4096
  ds_read_b128 v[88:91], v14 offset:6144
  ds_read_b128 v[92:95], v14 offset:8192
  ds_read_b128 v[96:99], v14 offset:10240
  ds_read_b128 v[100:103], v14 offset:12288
  ds_read_b128 v[104:107], v14 offset:14336
  s_waitcnt lgkmcnt(0)
  v_add_f32 v68, v76, v80
  v_add_f32 v68, v68, v84
  v_add_f32 v68, v68, v88
  v_add_f32 v68, v68, v92
  v_add_f32 v68, v68, v96
  v_add_f32 v68, v68, v100
  v_add_f32 v68, v68, v104
  v_add_f32 v69, v77, v81
  v_add_f32 v69, v69, v85
  v_add_f32 v69, v69, v89
  v_add_f32 v69, v69, v93
  v_add_f32 v69, v69, v97
  v_add_f32 v69, v69, v101
  v_add_f32 v69, v69, v105
  v_add_f32 v70, v78, v82
  v_add_f32 v70, v70, v86
  v_add_f32 v70, v70, v90
  v_add_f32 v70, v70, v94
  v_add_f32 v70, v70, v98
  v_add_f32 v70, v70, v102
  v_add_f32 v70, v70, v106
  v_add_f32 v71, v79, v83
  v_add_f32 v71, v71, v87
  v_add_f32 v71, v71, v91
  v_add_f32 v71, v71, v95
  v_add_f32 v71, v71, v99
  v_add_f32 v71, v71, v103
  v_add_f32 v71, v71, v107
  ds_read_b128 v[76:79], v14 offset:1024
  ds_read_b128 v[80:83], v14 offset:3072
  ds_read_b128 v[84:87], v14 offset:5120
  ds_read_b128 v[88:91], v14 offset:7168
  ds_read_b128 v[92:95], v14 offset:9216
  ds_read_b128 v[96:99], v14 offset:11264
  ds_read_b128 v[100:103], v14 offset:13312
  ds_read_b128 v[104:107], v14 offset:15360
  s_waitcnt lgkmcnt(0)
  v_add_f32 v72, v76, v80
  v_add_f32 v72, v72, v84
  v_add_f32 v72, v72, v88
  v_add_f32 v72, v72, v92
  v_add_f32 v72, v72, v96
  v_add_f32 v72, v72, v100
  v_add_f32 v72, v72, v104
  v_add_f32 v73, v77, v81
  v_add_f32 v73, v73, v85
  v_add_f32 v73, v73, v89
  v_add_f32 v73, v73, v93
  v_add_f32 v73, v73, v97
  v_add_f32 v73, v73, v101
  v_add_f32 v73, v73, v105
  v_add_f32 v74, v78, v82
  v_add_f32 v74, v74, v86
  v_add_f32 v74, v74, v90
  v_add_f32 v74, v74, v94
  v_add_f32 v74, v74, v98
  v_add_f32 v74, v74, v102
  v_add_f32 v74, v74, v106
  v_add_f32 v75, v79, v83
  v_add_f32 v75, v75, v87
  v_add_f32 v75, v75, v91
  v_add_f32 v75, v75, v95
  v_add_f32 v75, v75, v99
  v_add_f32 v75, v75, v103
  v_add_f32 v75, v75, v107
  s_lshl_b32 s64, s61, 1
  s_add_u32 s64, s64, s62
  s_lshl_b32 s64, s64, 5
  s_add_u32 s64, s64, s60
  s_lshl_b32 s64, s64, 11
  v_add_u32 v14, s64, v3
  v_mov_b32 v40, -1
  v_mov_b32 v41, -1
  v_mov_b32 v42, -1
  v_mov_b32 v43, -1
  global_store_dwordx4 v14, v[40:43], s[30:31] sc1
  global_store_dwordx4 v14, v[40:43], s[30:31] offset:1024 sc1
  s_lshl_b32 s64, s60, 1
  s_add_u32 s64, s64, s62
  s_lshl_b32 s64, s64, 2
  s_add_u32 s64, s64, s61
  s_lshl_b32 s64, s64, 11
  s_add_u32 s64, s64, 524288
  v_add_u32 v14, s64, v3
  global_store_dwordx4 v14, v[68:71], s[30:31] sc1
  global_store_dwordx4 v14, v[72:75], s[30:31] offset:1024 sc1
  s_lshl_b32 s65, s60, 2
  v_mov_b32 v32, s65
  s_mov_b32 s78, 0
L_tpoll4:
  s_mov_b64 exec, 1
  global_load_dword v33, v32, s[28:29] sc1
  s_mov_b64 exec, -1
  s_waitcnt vmcnt(0)
  v_readfirstlane_b32 s79, v33
  s_add_u32 s78, s78, 1
  s_cmp_gt_u32 s78, 0x200000
  s_cbranch_scc1 L_tpoll4x
  s_cmp_eq_u32 s79, 0
  s_cbranch_scc1 L_tpoll4
L_tpoll4x:
  s_lshl_b32 s64, s62, 2
  s_add_u32 s64, s64, s61
  s_lshl_b32 s64, s64, 3
  s_lshl_b32 s65, s60, 8
  s_add_u32 s65, s65, 1310720
  s_add_u32 s64, s64, s65
  v_mov_b32 v36, s79
  v_not_b32 v37, v36
  v_mov_b32 v32, s64
  s_mov_b64 exec, 1
  global_store_dwordx2 v32, v[36:37], s[30:31] sc1
  s_mov_b64 exec, -1
  v_lshlrev_b32 v32, 3, v1
  v_add_u32 v32, s65, v32
  v_lshrrev_b32 v14, 5, v1
  v_lshlrev_b32 v14, 13, v14
  v_and_b32 v34, 31, v1
  v_lshl_add_u32 v14, v34, 4, v14
  s_lshl_b32 s64, s60, 14
  s_lshl_b32 s66, s61, 9
  s_add_u32 s64, s64, s66
  s_add_u32 s64, s64, 524288
  v_add_u32 v14, s64, v14
  v_add_u32 v35, 0x1000, v14
  s_mov_b32 s78, 0
  s_cmp_eq_u32 s62, 0
  s_cselect_b32 s66, 0xf, 0xff
L_qpoll5:
  s_mov_b64 exec, 0xff
  global_load_dwordx2 v[38:39], v32, s[30:31] sc1
  s_waitcnt vmcnt(0)
  v_cmp_eq_u64 vcc, v[38:39], v[36:37]
  s_mov_b64 exec, -1
  s_and_b32 s64, vcc_lo, s66
  s_add_u32 s78, s78, 1
  s_cmp_gt_u32 s78, 0x200000
  s_cbranch_scc1 L_qpoll5x
  s_cmp_lg_u32 s64, s66
  s_cbranch_scc1 L_qpoll5
L_qpoll5x:
  global_load_dwordx4 v[76:79], v14, s[30:31] offset:0 sc1
  global_load_dwordx4 v[80:83], v14, s[30:31] offset:2048 sc1
  global_load_dwordx4 v[84:87], v35, s[30:31] offset:0 sc1
  global_load_dwordx4 v[88:91], v35, s[30:31] offset:2048 sc1
  s_lshl_b32 s64, s3, 14
  global_load_dwordx4 v[132:135], v2, s[32:33] offset:-2048 nt
  global_load_dwordx4 v[136:139], v2, s[32:33] offset:-1024 nt
  global_load_dwordx4 v[140:143], v2, s[32:33] offset:0 nt
  global_load_dwordx4 v[144:147], v2, s[32:33] offset:1024 nt
  global_load_dwordx4 v[148:151], v2, s[32:33] offset:2048 nt
  global_load_dwordx4 v[152:155], v2, s[32:33] offset:3072 nt
  s_add_u32 s32, s32, 0x10000
  s_addc_u32 s33, s33, 0
  global_load_dwordx4 v[156:159], v2, s[32:33] offset:-4096 nt
  global_load_dwordx4 v[160:163], v2, s[32:33] offset:-3072 nt
  global_load_dwordx4 v[164:167], v2, s[32:33] offset:-2048 nt
  global_load_dwordx4 v[168:171], v2, s[32:33] offset:-1024 nt
  global_load_dwordx4 v[172:175], v2, s[32:33] offset:0 nt
  global_load_dwordx4 v[176:179], v2, s[32:33] offset:1024 nt
  global_load_dwordx4 v[180:183], v2, s[32:33] offset:2048 nt
  global_load_dwordx4 v[184:187], v2, s[32:33] offset:3072 nt
  s_add_u32 s32, s32, 0x10000
  s_addc_u32 s33, s33, 0
  global_load_dwordx4 v[188:191], v2, s[32:33] offset:-4096 nt
  global_load_dwordx4 v[192:195], v2, s[32:33] offset:-3072 nt
  global_load_dwordx4 v[196:199], v2, s[32:33] offset:-2048 nt
  global_load_dwordx4 v[200:203], v2, s[32:33] offset:-1024 nt
  global_load_dwordx4 v[204:207], v2, s[32:33] offset:0 nt
  global_load_dwordx4 v[208:211], v2, s[32:33] offset:1024 nt
  global_load_dwordx4 v[212:215], v2, s[32:33] offset:2048 nt
  global_load_dwordx4 v[216:219], v2, s[32:33] offset:3072 nt
  s_add_u32 s32, s32, 0x10000
  s_addc_u32 s33, s33, 0
  global_load_dwordx4 v[220:223], v2, s[32:33] offset:-4096 nt
  global_load_dwordx4 v[224:227], v2, s[32:33] offset:-3072 nt
  global_load_dwordx4 v[228:231], v2, s[32:33] offset:-2048 nt
  global_load_dwordx4 v[232:235], v2, s[32:33] offset:-1024 nt
  global_load_dwordx4 v[236:239], v2, s[32:33] offset:0 nt
  global_load_dwordx4 v[240:243], v2, s[32:33] offset:1024 nt
  global_load_dwordx4 v[244:247], v2, s[32:33] offset:2048 nt
  global_load_dwordx4 v[248:251], v2, s[32:33] offset:3072 nt
  s_add_u32 s32, s32, 0x10000
  s_addc_u32 s33, s33, 0
  s_waitcnt vmcnt(30)
  v_add_f32 v76, v76, v80
  v_add_f32 v84, v84, v88
  v_add_f32 v76, v76, v84
  v_add_f32 v77, v77, v81
  v_add_f32 v85, v85, v89
  v_add_f32 v77, v77, v85
  v_add_f32 v78, v78, v82
  v_add_f32 v86, v86, v90
  v_add_f32 v78, v78, v86
  v_add_f32 v79, v79, v83
  v_add_f32 v87, v87, v91
  v_add_f32 v79, v79, v87
  v_cvt_pk_bf16_f32 v80, v76, v77
  v_cvt_pk_bf16_f32 v81, v78, v79
  v_lshlrev_b32 v14, 3, v1
  v_add_u32 v14, 147456, v14
  ds_write_b64 v14, v[80:81]
  s_waitcnt lgkmcnt(0)
  s_barrier
  s_branch L_qdone2
L_pf3:
  s_lshl_b32 s64, s3, 14
  s_waitcnt vmcnt(3)
  global_load_dwordx4 v[132:135], v2, s[32:33] offset:-2048 nt
  s_waitcnt vmcnt(3)
  global_load_dwordx4 v[136:139], v2, s[32:33] offset:-1024 nt
  s_waitcnt vmcnt(3)
  global_load_dwordx4 v[140:143], v2, s[32:33] offset:0 nt
  s_waitcnt vmcnt(3)
  global_load_dwordx4 v[144:147], v2, s[32:33] offset:1024 nt
  s_waitcnt vmcnt(3)
  global_load_dwordx4 v[148:151], v2, s[32:33] offset:2048 nt
  s_waitcnt vmcnt(3)
  global_load_dwordx4 v[152:155], v2, s[32:33] offset:3072 nt
  s_add_u32 s32, s32, 0x10000
  s_addc_u32 s33, s33, 0
  s_waitcnt vmcnt(3)
  global_load_dwordx4 v[156:159], v2, s[32:33] offset:-4096 nt
  s_waitcnt vmcnt(3)
  global_load_dwordx4 v[160:163], v2, s[32:33] offset:-3072 nt
  s_waitcnt vmcnt(3)
  global_load_dwordx4 v[164:167], v2, s[32:33] offset:-2048 nt
  s_waitcnt vmcnt(3)
  global_load_dwordx4 v[168:171], v2, s[32:33] offset:-1024 nt
  s_waitcnt vmcnt(3)
  global_load_dwordx4 v[172:175], v2, s[32:33] offset:0 nt
  s_waitcnt vmcnt(3)
  global_load_dwordx4 v[176:179], v2, s[32:33] offset:1024 nt
  s_waitcnt vmcnt(3)
  global_load_dwordx4 v[180:183], v2, s[32:33] offset:2048 nt
  s_waitcnt vmcnt(3)
  global_load_dwordx4 v[184:187], v2, s[32:33] offset:3072 nt
  s_add_u32 s32, s32, 0x10000
  s_addc_u32 s33, s33, 0
  s_waitcnt vmcnt(3)
  global_load_dwordx4 v[188:191], v2, s[32:33] offset:-4096 nt
  s_waitcnt vmcnt(3)
  global_load_dwordx4 v[192:195], v2, s[32:33] offset:-3072 nt
  s_waitcnt vmcnt(3)
  global_load_dwordx4 v[196:199], v2, s[32:33] offset:-2048 nt
  s_waitcnt vmcnt(3)
  global_load_dwordx4 v[200:203], v2, s[32:33] offset:-1024 nt
  s_waitcnt vmcnt(3)
  global_load_dwordx4 v[204:207], v2, s[32:33] offset:0 nt
  s_waitcnt vmcnt(3)
  global_load_dwordx4 v[208:211], v2, s[32:33] offset:1024 nt
  s_waitcnt vmcnt(3)
  global_load_dwordx4 v[212:215], v2, s[32:33] offset:2048 nt
  s_waitcnt vmcnt(3)
  global_load_dwordx4 v[216:219], v2, s[32:33] offset:3072 nt
  s_add_u32 s32, s32, 0x10000
  s_addc_u32 s33, s33, 0
  s_waitcnt vmcnt(3)
  global_load_dwordx4 v[220:223], v2, s[32:33] offset:-4096 nt
  s_waitcnt vmcnt(3)
  global_load_dwordx4 v[224:227], v2, s[32:33] offset:-3072 nt
  s_waitcnt vmcnt(3)
  global_load_dwordx4 v[228:231], v2, s[32:33] offset:-2048 nt
  s_waitcnt vmcnt(3)
  global_load_dwordx4 v[232:235], v2, s[32:33] offset:-1024 nt
  s_waitcnt vmcnt(3)
  global_load_dwordx4 v[236:239], v2, s[32:33] offset:0 nt
  s_waitcnt vmcnt(3)
  global_load_dwordx4 v[240:243], v2, s[32:33] offset:1024 nt
  s_waitcnt vmcnt(3)
  global_load_dwordx4 v[244:247], v2, s[32:33] offset:2048 nt
  s_waitcnt vmcnt(3)
  global_load_dwordx4 v[248:251], v2, s[32:33] offset:3072 nt
  s_add_u32 s32, s32, 0x10000
  s_addc_u32 s33, s33, 0
  s_barrier
L_qdone2:
  v_and_b32 v14, 3, v10
  v_lshl_add_u32 v14, v11, 2, v14
  v_lshlrev_b32 v14, 4, v14
  v_add_u32 v14, 147456, v14
  ds_read_b128 v[76:79], v14 offset:0
  s_waitcnt lgkmcnt(0)
  v_cndmask_b32 v16, 0, v76, s[50:51]
  v_cndmask_b32 v17, 0, v77, s[50:51]
  v_cndmask_b32 v18, 0, v78, s[50:51]
  v_cndmask_b32 v19, 0, v79, s[50:51]
  v_cndmask_b32 v20, 0, v76, s[52:53]
  v_cndmask_b32 v21, 0, v77, s[52:53]
  v_cndmask_b32 v22, 0, v78, s[52:53]
  v_cndmask_b32 v23, 0, v79, s[52:53]
  v_cndmask_b32 v24, 0, v76, s[54:55]
  v_cndmask_b32 v25, 0, v77, s[54:55]
  v_cndmask_b32 v26, 0, v78, s[54:55]
  v_cndmask_b32 v27, 0, v79, s[54:55]
  v_cndmask_b32 v28, 0, v76, s[56:57]
  v_cndmask_b32 v29, 0, v77, s[56:57]
  v_cndmask_b32 v30, 0, v78, s[56:57]
  v_cndmask_b32 v31, 0, v79, s[56:57]
  s_nop 1
  s_cmp_lg_u32 s62, 0
  s_cbranch_scc1 L_pathS
  s_waitcnt vmcnt(31)
  v_mfma_f32_16x16x32_bf16 v[32:35], v[124:127], v[16:19], 0
  global_load_dwordx4 v[124:127], v2, s[32:33] offset:-4096 nt
  s_lshl_b32 s64, s3, 14
  s_add_u32 m0, s64, 0
  s_nop 0
  global_load_lds_dwordx4 v5, s[42:43] nt
  s_add_u32 s42, s42, 0x2000
  s_addc_u32 s43, s43, 0
  s_waitcnt vmcnt(32)
  v_mfma_f32_16x16x32_bf16 v[32:35], v[128:131], v[20:23], v[32:35]
  global_load_dwordx4 v[128:131], v2, s[32:33] offset:-3072 nt
  s_lshl_b32 s64, s3, 14
  s_add_u32 m0, s64, 1024
  s_nop 0
  global_load_lds_dwordx4 v5, s[42:43] nt
  s_add_u32 s42, s42, 0x2000
  s_addc_u32 s43, s43, 0
  s_waitcnt vmcnt(33)
  v_mfma_f32_16x16x32_bf16 v[32:35], v[132:135], v[24:27], v[32:35]
  global_load_dwordx4 v[132:135], v2, s[32:33] offset:-2048 nt
  s_lshl_b32 s64, s3, 14
  s_add_u32 m0, s64, 2048
  s_nop 0
  global_load_lds_dwordx4 v5, s[42:43] nt
  s_add_u32 s42, s42, 0x2000
  s_addc_u32 s43, s43, 0
  s_waitcnt vmcnt(34)
  v_mfma_f32_16x16x32_bf16 v[32:35], v[136:139], v[28:31], v[32:35]
  global_load_dwordx4 v[136:139], v2, s[32:33] offset:-1024 nt
  s_lshl_b32 s64, s3, 14
  s_add_u32 m0, s64, 3072
  s_nop 0
  global_load_lds_dwordx4 v5, s[42:43] nt
  s_add_u32 s42, s42, 0x2000
  s_addc_u32 s43, s43, 0
  s_waitcnt vmcnt(35)
  v_mfma_f32_16x16x32_bf16 v[36:39], v[140:143], v[16:19], 0
  global_load_dwordx4 v[140:143], v2, s[32:33] offset:0 nt
  s_lshl_b32 s64, s3, 14
  s_add_u32 m0, s64, 4096
  s_nop 0
  global_load_lds_dwordx4 v5, s[42:43] nt
  s_add_u32 s42, s42, 0x2000
  s_addc_u32 s43, s43, 0
  s_waitcnt vmcnt(36)
  v_mfma_f32_16x16x32_bf16 v[36:39], v[144:147], v[20:23], v[36:39]
  global_load_dwordx4 v[144:147], v2, s[32:33] offset:1024 nt
  s_lshl_b32 s64, s3, 14
  s_add_u32 m0, s64, 5120
  s_nop 0
  global_load_lds_dwordx4 v5, s[42:43] nt
  s_add_u32 s42, s42, 0x2000
  s_addc_u32 s43, s43, 0
  s_waitcnt vmcnt(37)
  v_mfma_f32_16x16x32_bf16 v[36:39], v[148:151], v[24:27], v[36:39]
  global_load_dwordx4 v[148:151], v2, s[32:33] offset:2048 nt
  s_lshl_b32 s64, s3, 14
  s_add_u32 m0, s64, 6144
  s_nop 0
  global_load_lds_dwordx4 v5, s[42:43] nt
  s_add_u32 s42, s42, 0x2000
  s_addc_u32 s43, s43, 0
  s_waitcnt vmcnt(38)
  v_mfma_f32_16x16x32_bf16 v[36:39], v[152:155], v[28:31], v[36:39]
  global_load_dwordx4 v[152:155], v2, s[32:33] offset:3072 nt
  s_add_u32 s32, s32, 0x10000
  s_addc_u32 s33, s33, 0
  s_lshl_b32 s64, s3, 14
  s_add_u32 m0, s64, 7168
  s_nop 0
  global_load_lds_dwordx4 v5, s[42:43] nt
  s_add_u32 s42, s42, 0x2000
  s_addc_u32 s43, s43, 0
  s_waitcnt vmcnt(39)
  v_mfma_f32_16x16x32_bf16 v[40:43], v[156:159], v[16:19], 0
  global_load_dwordx4 v[156:159], v2, s[32:33] offset:-4096 nt
  s_lshl_b32 s64, s3, 14
  s_add_u32 m0, s64, 8192
  s_nop 0
  global_load_lds_dwordx4 v5, s[42:43] nt
  s_add_u32 s42, s42, 0x2000
  s_addc_u32 s43, s43, 0
  s_waitcnt vmcnt(40)
  v_mfma_f32_16x16x32_bf16 v[40:43], v[160:163], v[20:23], v[40:43]
  global_load_dwordx4 v[160:163], v2, s[32:33] offset:-3072 nt
  s_lshl_b32 s64, s3, 14
  s_add_u32 m0, s64, 9216
  s_nop 0
  global_load_lds_dwordx4 v5, s[42:43] nt
  s_add_u32 s42, s42, 0x2000
  s_addc_u32 s43, s43, 0
  s_waitcnt vmcnt(41)
  v_mfma_f32_16x16x32_bf16 v[40:43], v[164:167], v[24:27], v[40:43]
  global_load_dwordx4 v[164:167], v2, s[32:33] offset:-2048 nt
  s_lshl_b32 s64, s3, 14
  s_add_u32 m0, s64, 10240
  s_nop 0
  global_load_lds_dwordx4 v5, s[42:43] nt
  s_add_u32 s42, s42, 0x2000
  s_addc_u32 s43, s43, 0
  s_waitcnt vmcnt(42)
  v_mfma_f32_16x16x32_bf16 v[40:43], v[168:171], v[28:31], v[40:43]
  global_load_dwordx4 v[168:171], v2, s[32:33] offset:-1024 nt
  s_lshl_b32 s64, s3, 14
  s_add_u32 m0, s64, 11264
  s_nop 0
  global_load_lds_dwordx4 v5, s[42:43] nt
  s_add_u32 s42, s42, 0x2000
  s_addc_u32 s43, s43, 0
  s_waitcnt vmcnt(43)
  v_mfma_f32_16x16x32_bf16 v[44:47], v[172:175], v[16:19], 0
  global_load_dwordx4 v[172:175], v2, s[32:33] offset:0 nt
  s_lshl_b32 s64, s3, 14
  s_add_u32 m0, s64, 12288
  s_nop 0
  global_load_lds_dwordx4 v5, s[42:43] nt
  s_add_u32 s42, s42, 0x2000
  s_addc_u32 s43, s43, 0
  s_waitcnt vmcnt(44)
  v_mfma_f32_16x16x32_bf16 v[44:47], v[176:179], v[20:23], v[44:47]
  global_load_dwordx4 v[176:179], v2, s[32:33] offset:1024 nt
  s_lshl_b32 s64, s3, 14
  s_add_u32 m0, s64, 13312
  s_nop 0
  global_load_lds_dwordx4 v5, s[42:43] nt
  s_add_u32 s42, s42, 0x2000
  s_addc_u32 s43, s43, 0
  s_waitcnt vmcnt(45)
  v_mfma_f32_16x16x32_bf16 v[44:47], v[180:183], v[24:27], v[44:47]
  global_load_dwordx4 v[180:183], v2, s[32:33] offset:2048 nt
  s_lshl_b32 s64, s3, 14
  s_add_u32 m0, s64, 14336
  s_nop 0
  global_load_lds_dwordx4 v5, s[42:43] nt
  s_add_u32 s42, s42, 0x2000
  s_addc_u32 s43, s43, 0
  s_waitcnt vmcnt(46)
  v_mfma_f32_16x16x32_bf16 v[44:47], v[184:187], v[28:31], v[44:47]
  global_load_dwordx4 v[184:187], v2, s[32:33] offset:3072 nt
  s_add_u32 s32, s32, 0x10000
  s_addc_u32 s33, s33, 0
  s_lshl_b32 s64, s3, 14
  s_add_u32 m0, s64, 15360
  s_nop 0
  global_load_lds_dwordx4 v5, s[42:43] nt
  s_nop 7
  v_mov_b32_dpp v76, v32 quad_perm:[0,0,0,0] row_mask:0xf bank_mask:0xf
  v_add_f32_dpp v76, v33, v76 quad_perm:[1,1,1,1] row_mask:0xf bank_mask:0xf
  v_add_f32_dpp v76, v34, v76 quad_perm:[2,2,2,2] row_mask:0xf bank_mask:0xf
  v_add_f32_dpp v76, v35, v76 quad_perm:[3,3,3,3] row_mask:0xf bank_mask:0xf
  v_mov_b32_dpp v77, v36 quad_perm:[0,0,0,0] row_mask:0xf bank_mask:0xf
  v_add_f32_dpp v77, v37, v77 quad_perm:[1,1,1,1] row_mask:0xf bank_mask:0xf
  v_add_f32_dpp v77, v38, v77 quad_perm:[2,2,2,2] row_mask:0xf bank_mask:0xf
  v_add_f32_dpp v77, v39, v77 quad_perm:[3,3,3,3] row_mask:0xf bank_mask:0xf
  v_mov_b32_dpp v78, v40 quad_perm:[0,0,0,0] row_mask:0xf bank_mask:0xf
  v_add_f32_dpp v78, v41, v78 quad_perm:[1,1,1,1] row_mask:0xf bank_mask:0xf
  v_add_f32_dpp v78, v42, v78 quad_perm:[2,2,2,2] row_mask:0xf bank_mask:0xf
  v_add_f32_dpp v78, v43, v78 quad_perm:[3,3,3,3] row_mask:0xf bank_mask:0xf
  v_mov_b32_dpp v79, v44 quad_perm:[0,0,0,0] row_mask:0xf bank_mask:0xf
  v_add_f32_dpp v79, v45, v79 quad_perm:[1,1,1,1] row_mask:0xf bank_mask:0xf
  v_add_f32_dpp v79, v46, v79 quad_perm:[2,2,2,2] row_mask:0xf bank_mask:0xf
  v_add_f32_dpp v79, v47, v79 quad_perm:[3,3,3,3] row_mask:0xf bank_mask:0xf
  v_cndmask_b32 v48, v76, v77, s[44:45]
  v_cndmask_b32 v48, v48, v78, s[46:47]
  v_cndmask_b32 v48, v48, v79, s[48:49]
  s_lshl_b32 s64, s61, 10
  v_add_u32 v14, s64, v3
  global_load_dwordx4 v[84:87], v14, s[8:9]
  global_load_dwordx4 v[88:91], v3, s[4:5]
  s_waitcnt vmcnt(49)
  v_mfma_f32_16x16x32_bf16 v[32:35], v[188:191], v[16:19], 0
  global_load_dwordx4 v[188:191], v2, s[32:33] offset:-4096 nt
  s_waitcnt vmcnt(49)
  v_mfma_f32_16x16x32_bf16 v[32:35], v[192:195], v[20:23], v[32:35]
  global_load_dwordx4 v[192:195], v2, s[32:33] offset:-3072 nt
  s_waitcnt vmcnt(49)
  v_mfma_f32_16x16x32_bf16 v[32:35], v[196:199], v[24:27], v[32:35]
  global_load_dwordx4 v[196:199], v2, s[32:33] offset:-2048 nt
  s_waitcnt vmcnt(49)
  v_mfma_f32_16x16x32_bf16 v[32:35], v[200:203], v[28:31], v[32:35]
  global_load_dwordx4 v[200:203], v2, s[32:33] offset:-1024 nt
  s_waitcnt vmcnt(49)
  v_mfma_f32_16x16x32_bf16 v[36:39], v[204:207], v[16:19], 0
  global_load_dwordx4 v[204:207], v2, s[32:33] offset:0 nt
  s_waitcnt vmcnt(49)
  v_mfma_f32_16x16x32_bf16 v[36:39], v[208:211], v[20:23], v[36:39]
  global_load_dwordx4 v[208:211], v2, s[32:33] offset:1024 nt
  s_waitcnt vmcnt(49)
  v_mfma_f32_16x16x32_bf16 v[36:39], v[212:215], v[24:27], v[36:39]
  global_load_dwordx4 v[212:215], v2, s[32:33] offset:2048 nt
  s_waitcnt vmcnt(49)
  v_mfma_f32_16x16x32_bf16 v[36:39], v[216:219], v[28:31], v[36:39]
  global_load_dwordx4 v[216:219], v2, s[32:33] offset:3072 nt
  s_add_u32 s32, s32, 0x10000
  s_addc_u32 s33, s33, 0
  s_waitcnt vmcnt(49)
  v_mfma_f32_16x16x32_bf16 v[40:43], v[220:223], v[16:19], 0
  global_load_dwordx4 v[220:223], v2, s[32:33] offset:-4096 nt
  s_waitcnt vmcnt(49)
  v_mfma_f32_16x16x32_bf16 v[40:43], v[224:227], v[20:23], v[40:43]
  global_load_dwordx4 v[224:227], v2, s[32:33] offset:-3072 nt
  s_waitcnt vmcnt(49)
  v_mfma_f32_16x16x32_bf16 v[40:43], v[228:231], v[24:27], v[40:43]
  global_load_dwordx4 v[228:231], v2, s[32:33] offset:-2048 nt
  s_waitcnt vmcnt(49)
  v_mfma_f32_16x16x32_bf16 v[40:43], v[232:235], v[28:31], v[40:43]
  global_load_dwordx4 v[232:235], v2, s[32:33] offset:-1024 nt
  s_waitcnt vmcnt(49)
  v_mfma_f32_16x16x32_bf16 v[44:47], v[236:239], v[16:19], 0
  global_load_dwordx4 v[236:239], v2, s[32:33] offset:0 nt
  s_waitcnt vmcnt(49)
  v_mfma_f32_16x16x32_bf16 v[44:47], v[240:243], v[20:23], v[44:47]
  global_load_dwordx4 v[240:243], v2, s[32:33] offset:1024 nt
  s_waitcnt vmcnt(49)
  v_mfma_f32_16x16x32_bf16 v[44:47], v[244:247], v[24:27], v[44:47]
  global_load_dwordx4 v[244:247], v2, s[32:33] offset:2048 nt
  s_waitcnt vmcnt(49)
  v_mfma_f32_16x16x32_bf16 v[44:47], v[248:251], v[28:31], v[44:47]
  global_load_dwordx4 v[248:251], v2, s[32:33] offset:3072 nt
  s_add_u32 s32, s32, 0x10000
  s_addc_u32 s33, s33, 0
  s_nop 7
  v_mov_b32_dpp v76, v32 quad_perm:[0,0,0,0] row_mask:0xf bank_mask:0xf
  v_add_f32_dpp v76, v33, v76 quad_perm:[1,1,1,1] row_mask:0xf bank_mask:0xf
  v_add_f32_dpp v76, v34, v76 quad_perm:[2,2,2,2] row_mask:0xf bank_mask:0xf
  v_add_f32_dpp v76, v35, v76 quad_perm:[3,3,3,3] row_mask:0xf bank_mask:0xf
  v_mov_b32_dpp v77, v36 quad_perm:[0,0,0,0] row_mask:0xf bank_mask:0xf
  v_add_f32_dpp v77, v37, v77 quad_perm:[1,1,1,1] row_mask:0xf bank_mask:0xf
  v_add_f32_dpp v77, v38, v77 quad_perm:[2,2,2,2] row_mask:0xf bank_mask:0xf
  v_add_f32_dpp v77, v39, v77 quad_perm:[3,3,3,3] row_mask:0xf bank_mask:0xf
  v_mov_b32_dpp v78, v40 quad_perm:[0,0,0,0] row_mask:0xf bank_mask:0xf
  v_add_f32_dpp v78, v41, v78 quad_perm:[1,1,1,1] row_mask:0xf bank_mask:0xf
  v_add_f32_dpp v78, v42, v78 quad_perm:[2,2,2,2] row_mask:0xf bank_mask:0xf
  v_add_f32_dpp v78, v43, v78 quad_perm:[3,3,3,3] row_mask:0xf bank_mask:0xf
  v_mov_b32_dpp v79, v44 quad_perm:[0,0,0,0] row_mask:0xf bank_mask:0xf
  v_add_f32_dpp v79, v45, v79 quad_perm:[1,1,1,1] row_mask:0xf bank_mask:0xf
  v_add_f32_dpp v79, v46, v79 quad_perm:[2,2,2,2] row_mask:0xf bank_mask:0xf
  v_add_f32_dpp v79, v47, v79 quad_perm:[3,3,3,3] row_mask:0xf bank_mask:0xf
  v_cndmask_b32 v49, v76, v77, s[44:45]
  v_cndmask_b32 v49, v49, v78, s[46:47]
  v_cndmask_b32 v49, v49, v79, s[48:49]
  s_waitcnt vmcnt(49)
  v_mfma_f32_16x16x32_bf16 v[32:35], v[124:127], v[16:19], 0
  global_load_dwordx4 v[124:127], v2, s[32:33] offset:-4096 nt
  s_cmp_lg_u32 s3, 0
  s_cbranch_scc1 L_vi6
  v_and_b32 v108, 31, v1
  v_lshlrev_b32 v109, 8, v108
  v_lshlrev_b32 v108, 2, v108
  v_lshrrev_b32 v110, 5, v1
  v_lshl_add_u32 v109, v110, 5, v109
  s_lshl_b32 s65, s61, 3
  s_add_u32 s65, s65, 1310720
  v_add_u32 v109, s65, v109
  global_load_dword v110, v108, s[28:29] sc1
  global_load_dwordx2 v[112:113], v109, s[30:31] sc1
L_vi6:
  s_waitcnt vmcnt(48)
  v_mfma_f32_16x16x32_bf16 v[32:35], v[128:131], v[20:23], v[32:35]
  global_load_dwordx4 v[128:131], v2, s[32:33] offset:-3072 nt
  s_waitcnt vmcnt(47)
  v_mfma_f32_16x16x32_bf16 v[32:35], v[132:135], v[24:27], v[32:35]
  global_load_dwordx4 v[132:135], v2, s[32:33] offset:-2048 nt
  s_waitcnt vmcnt(46)
  v_mfma_f32_16x16x32_bf16 v[32:35], v[136:139], v[28:31], v[32:35]
  global_load_dwordx4 v[136:139], v2, s[32:33] offset:-1024 nt
  s_waitcnt vmcnt(45)
  v_mfma_f32_16x16x32_bf16 v[36:39], v[140:143], v[16:19], 0
  global_load_dwordx4 v[140:143], v2, s[32:33] offset:0 nt
  s_waitcnt vmcnt(44)
  v_mfma_f32_16x16x32_bf16 v[36:39], v[144:147], v[20:23], v[36:39]
  global_load_dwordx4 v[144:147], v2, s[32:33] offset:1024 nt
  s_waitcnt vmcnt(43)
  v_mfma_f32_16x16x32_bf16 v[36:39], v[148:151], v[24:27], v[36:39]
  global_load_dwordx4 v[148:151], v2, s[32:33] offset:2048 nt
  s_waitcnt vmcnt(42)
  v_mfma_f32_16x16x32_bf16 v[36:39], v[152:155], v[28:31], v[36:39]
  global_load_dwordx4 v[152:155], v2, s[32:33] offset:3072 nt
  s_add_u32 s32, s32, 0x10000
  s_addc_u32 s33, s33, 0
  s_waitcnt vmcnt(41)
  v_mfma_f32_16x16x32_bf16 v[40:43], v[156:159], v[16:19], 0
  global_load_dwordx4 v[156:159], v2, s[32:33] offset:-4096 nt
  s_waitcnt vmcnt(40)
  v_mfma_f32_16x16x32_bf16 v[40:43], v[160:163], v[20:23], v[40:43]
  global_load_dwordx4 v[160:163], v2, s[32:33] offset:-3072 nt
  s_waitcnt vmcnt(39)
  v_mfma_f32_16x16x32_bf16 v[40:43], v[164:167], v[24:27], v[40:43]
  global_load_dwordx4 v[164:167], v2, s[32:33] offset:-2048 nt
  s_waitcnt vmcnt(38)
  v_mfma_f32_16x16x32_bf16 v[40:43], v[168:171], v[28:31], v[40:43]
  global_load_dwordx4 v[168:171], v2, s[32:33] offset:-1024 nt
  s_waitcnt vmcnt(37)
  v_mfma_f32_16x16x32_bf16 v[44:47], v[172:175], v[16:19], 0
  global_load_dwordx4 v[172:175], v2, s[32:33] offset:0 nt
  s_waitcnt vmcnt(36)
  v_mfma_f32_16x16x32_bf16 v[44:47], v[176:179], v[20:23], v[44:47]
  global_load_dwordx4 v[176:179], v2, s[32:33] offset:1024 nt
  s_waitcnt vmcnt(35)
  v_mfma_f32_16x16x32_bf16 v[44:47], v[180:183], v[24:27], v[44:47]
  global_load_dwordx4 v[180:183], v2, s[32:33] offset:2048 nt
  s_waitcnt vmcnt(34)
  v_mfma_f32_16x16x32_bf16 v[44:47], v[184:187], v[28:31], v[44:47]
  global_load_dwordx4 v[184:187], v2, s[32:33] offset:3072 nt
  s_add_u32 s32, s32, 0x10000
  s_addc_u32 s33, s33, 0
  s_nop 7
  v_mov_b32_dpp v76, v32 quad_perm:[0,0,0,0] row_mask:0xf bank_mask:0xf
  v_add_f32_dpp v76, v33, v76 quad_perm:[1,1,1,1] row_mask:0xf bank_mask:0xf
  v_add_f32_dpp v76, v34, v76 quad_perm:[2,2,2,2] row_mask:0xf bank_mask:0xf
  v_add_f32_dpp v76, v35, v76 quad_perm:[3,3,3,3] row_mask:0xf bank_mask:0xf
  v_mov_b32_dpp v77, v36 quad_perm:[0,0,0,0] row_mask:0xf bank_mask:0xf
  v_add_f32_dpp v77, v37, v77 quad_perm:[1,1,1,1] row_mask:0xf bank_mask:0xf
  v_add_f32_dpp v77, v38, v77 quad_perm:[2,2,2,2] row_mask:0xf bank_mask:0xf
  v_add_f32_dpp v77, v39, v77 quad_perm:[3,3,3,3] row_mask:0xf bank_mask:0xf
  v_mov_b32_dpp v78, v40 quad_perm:[0,0,0,0] row_mask:0xf bank_mask:0xf
  v_add_f32_dpp v78, v41, v78 quad_perm:[1,1,1,1] row_mask:0xf bank_mask:0xf
  v_add_f32_dpp v78, v42, v78 quad_perm:[2,2,2,2] row_mask:0xf bank_mask:0xf
  v_add_f32_dpp v78, v43, v78 quad_perm:[3,3,3,3] row_mask:0xf bank_mask:0xf
  v_mov_b32_dpp v79, v44 quad_perm:[0,0,0,0] row_mask:0xf bank_mask:0xf
  v_add_f32_dpp v79, v45, v79 quad_perm:[1,1,1,1] row_mask:0xf bank_mask:0xf
  v_add_f32_dpp v79, v46, v79 quad_perm:[2,2,2,2] row_mask:0xf bank_mask:0xf
  v_add_f32_dpp v79, v47, v79 quad_perm:[3,3,3,3] row_mask:0xf bank_mask:0xf
  v_cndmask_b32 v50, v76, v77, s[44:45]
  v_cndmask_b32 v50, v50, v78, s[46:47]
  v_cndmask_b32 v50, v50, v79, s[48:49]
  s_waitcnt vmcnt(32)
  v_mov_b32 v81, 0
  v_lshlrev_b32 v76, 16, v84
  v_lshlrev_b32 v77, 16, v88
  v_mul_f32 v76, v76, v77
  v_and_b32 v78, 0xffff0000, v84
  v_and_b32 v79, 0xffff0000, v88
  v_mul_f32 v78, v78, v79
  v_cvt_pk_bf16_f32 v76, v76, v78
  v_lshlrev_b32 v77, 16, v76
  v_and_b32 v78, 0xffff0000, v76
  v_add_f32 v81, v81, v77
  v_add_f32 v81, v81, v78
  v_lshlrev_b32 v76, 16, v85
  v_lshlrev_b32 v77, 16, v89
  v_mul_f32 v76, v76, v77
  v_and_b32 v78, 0xffff0000, v85
  v_and_b32 v79, 0xffff0000, v89
  v_mul_f32 v78, v78, v79
  v_cvt_pk_bf16_f32 v76, v76, v78
  v_lshlrev_b32 v77, 16, v76
  v_and_b32 v78, 0xffff0000, v76
  v_add_f32 v81, v81, v77
  v_add_f32 v81, v81, v78
  v_lshlrev_b32 v76, 16, v86
  v_lshlrev_b32 v77, 16, v90
  v_mul_f32 v76, v76, v77
  v_and_b32 v78, 0xffff0000, v86
  v_and_b32 v79, 0xffff0000, v90
  v_mul_f32 v78, v78, v79
  v_cvt_pk_bf16_f32 v76, v76, v78
  v_lshlrev_b32 v77, 16, v76
  v_and_b32 v78, 0xffff0000, v76
  v_add_f32 v81, v81, v77
  v_add_f32 v81, v81, v78
  v_lshlrev_b32 v76, 16, v87
  v_lshlrev_b32 v77, 16, v91
  v_mul_f32 v76, v76, v77
  v_and_b32 v78, 0xffff0000, v87
  v_and_b32 v79, 0xffff0000, v91
  v_mul_f32 v78, v78, v79
  v_cvt_pk_bf16_f32 v76, v76, v78
  v_lshlrev_b32 v77, 16, v76
  v_and_b32 v78, 0xffff0000, v76
  v_add_f32 v81, v81, v77
  v_add_f32 v81, v81, v78
  s_nop 1
  v_add_f32_dpp v81, v81, v81 row_ror:8 row_mask:0xf bank_mask:0xf
  s_nop 1
  v_add_f32_dpp v81, v81, v81 row_ror:4 row_mask:0xf bank_mask:0xf
  s_nop 1
  v_add_f32_dpp v81, v81, v81 row_ror:2 row_mask:0xf bank_mask:0xf
  s_nop 1
  v_add_f32_dpp v81, v81, v81 row_ror:1 row_mask:0xf bank_mask:0xf
  s_nop 1
  v_add_f32_dpp v81, v81, v81 row_bcast:15 row_mask:0xa bank_mask:0xf
  s_nop 1
  v_add_f32_dpp v81, v81, v81 row_bcast:31 row_mask:0xc bank_mask:0xf
  s_nop 0
  v_readlane_b32 s64, v81, 63
  s_nop 1
  v_mov_b32 v15, s64
  v_cvt_pk_bf16_f32 v15, v15, v15
  v_and_b32 v15, 0xffff0000, v15
  v_mul_f32 v15, v12, v15
  v_exp_f32 v15, -v15
  s_nop 0
  v_add_f32 v15, 1.0, v15
  v_rcp_f32 v15, v15
  s_nop 0
  v_cvt_pk_bf16_f32 v15, v15, v15
  v_and_b32 v15, 0xffff0000, v15
  v_sub_f32 v0, 1.0, v15
  v_cvt_pk_bf16_f32 v0, v0, v0
  v_and_b32 v0, 0xffff0000, v0
  s_waitcnt vmcnt(31)
  v_mfma_f32_16x16x32_bf16 v[32:35], v[188:191], v[16:19], 0
  global_load_dwordx4 v[188:191], v3, s[34:35] offset:-4096 nt
  s_waitcnt vmcnt(31)
  v_mfma_f32_16x16x32_bf16 v[32:35], v[192:195], v[20:23], v[32:35]
  global_load_dwordx4 v[192:195], v3, s[34:35] offset:-3072 nt
  s_waitcnt vmcnt(31)
  v_mfma_f32_16x16x32_bf16 v[32:35], v[196:199], v[24:27], v[32:35]
  global_load_dwordx4 v[196:199], v3, s[34:35] offset:-2048 nt
  s_waitcnt vmcnt(31)
  v_mfma_f32_16x16x32_bf16 v[32:35], v[200:203], v[28:31], v[32:35]
  global_load_dwordx4 v[200:203], v3, s[34:35] offset:-1024 nt
  s_waitcnt vmcnt(31)
  v_mfma_f32_16x16x32_bf16 v[36:39], v[204:207], v[16:19], 0
  global_load_dwordx4 v[204:207], v3, s[34:35] offset:0 nt
  s_waitcnt vmcnt(31)
  v_mfma_f32_16x16x32_bf16 v[36:39], v[208:211], v[20:23], v[36:39]
  global_load_dwordx4 v[208:211], v3, s[34:35] offset:1024 nt
  s_waitcnt vmcnt(31)
  v_mfma_f32_16x16x32_bf16 v[36:39], v[212:215], v[24:27], v[36:39]
  global_load_dwordx4 v[212:215], v3, s[34:35] offset:2048 nt
  s_waitcnt vmcnt(31)
  v_mfma_f32_16x16x32_bf16 v[36:39], v[216:219], v[28:31], v[36:39]
  global_load_dwordx4 v[216:219], v3, s[34:35] offset:3072 nt
  s_add_u32 s34, s34, 0x10000
  s_addc_u32 s35, s35, 0
  s_waitcnt vmcnt(31)
  v_mfma_f32_16x16x32_bf16 v[40:43], v[220:223], v[16:19], 0
  global_load_dwordx4 v[220:223], v3, s[34:35] offset:-4096 nt
  s_waitcnt vmcnt(31)
  v_mfma_f32_16x16x32_bf16 v[40:43], v[224:227], v[20:23], v[40:43]
  global_load_dwordx4 v[224:227], v3, s[34:35] offset:-3072 nt
  s_waitcnt vmcnt(31)
  v_mfma_f32_16x16x32_bf16 v[40:43], v[228:231], v[24:27], v[40:43]
  global_load_dwordx4 v[228:231], v3, s[34:35] offset:-2048 nt
  s_waitcnt vmcnt(31)
  v_mfma_f32_16x16x32_bf16 v[40:43], v[232:235], v[28:31], v[40:43]
  global_load_dwordx4 v[232:235], v3, s[34:35] offset:-1024 nt
  s_waitcnt vmcnt(31)
  v_mfma_f32_16x16x32_bf16 v[44:47], v[236:239], v[16:19], 0
  global_load_dwordx4 v[236:239], v3, s[34:35] offset:0 nt
  s_waitcnt vmcnt(31)
  v_mfma_f32_16x16x32_bf16 v[44:47], v[240:243], v[20:23], v[44:47]
  global_load_dwordx4 v[240:243], v3, s[34:35] offset:1024 nt
  s_waitcnt vmcnt(31)
  v_mfma_f32_16x16x32_bf16 v[44:47], v[244:247], v[24:27], v[44:47]
  global_load_dwordx4 v[244:247], v3, s[34:35] offset:2048 nt
  s_waitcnt vmcnt(31)
  v_mfma_f32_16x16x32_bf16 v[44:47], v[248:251], v[28:31], v[44:47]
  global_load_dwordx4 v[248:251], v3, s[34:35] offset:3072 nt
  s_add_u32 s34, s34, 0x10000
  s_addc_u32 s35, s35, 0
  s_nop 7
  v_mov_b32_dpp v76, v32 quad_perm:[0,0,0,0] row_mask:0xf bank_mask:0xf
  v_add_f32_dpp v76, v33, v76 quad_perm:[1,1,1,1] row_mask:0xf bank_mask:0xf
  v_add_f32_dpp v76, v34, v76 quad_perm:[2,2,2,2] row_mask:0xf bank_mask:0xf
  v_add_f32_dpp v76, v35, v76 quad_perm:[3,3,3,3] row_mask:0xf bank_mask:0xf
  v_mov_b32_dpp v77, v36 quad_perm:[0,0,0,0] row_mask:0xf bank_mask:0xf
  v_add_f32_dpp v77, v37, v77 quad_perm:[1,1,1,1] row_mask:0xf bank_mask:0xf
  v_add_f32_dpp v77, v38, v77 quad_perm:[2,2,2,2] row_mask:0xf bank_mask:0xf
  v_add_f32_dpp v77, v39, v77 quad_perm:[3,3,3,3] row_mask:0xf bank_mask:0xf
  v_mov_b32_dpp v78, v40 quad_perm:[0,0,0,0] row_mask:0xf bank_mask:0xf
  v_add_f32_dpp v78, v41, v78 quad_perm:[1,1,1,1] row_mask:0xf bank_mask:0xf
  v_add_f32_dpp v78, v42, v78 quad_perm:[2,2,2,2] row_mask:0xf bank_mask:0xf
  v_add_f32_dpp v78, v43, v78 quad_perm:[3,3,3,3] row_mask:0xf bank_mask:0xf
  v_mov_b32_dpp v79, v44 quad_perm:[0,0,0,0] row_mask:0xf bank_mask:0xf
  v_add_f32_dpp v79, v45, v79 quad_perm:[1,1,1,1] row_mask:0xf bank_mask:0xf
  v_add_f32_dpp v79, v46, v79 quad_perm:[2,2,2,2] row_mask:0xf bank_mask:0xf
  v_add_f32_dpp v79, v47, v79 quad_perm:[3,3,3,3] row_mask:0xf bank_mask:0xf
  v_cndmask_b32 v51, v76, v77, s[44:45]
  v_cndmask_b32 v51, v51, v78, s[46:47]
  v_cndmask_b32 v51, v51, v79, s[48:49]
  s_waitcnt vmcnt(31)
  v_mfma_f32_16x16x32_bf16 v[32:35], v[124:127], v[16:19], 0
  global_load_dwordx4 v[124:127], v3, s[34:35] offset:-4096 nt
  s_cmp_lg_u32 s3, 0
  s_cbranch_scc1 L_vc7
  s_mov_b32 s78, 0
L_vc7a:
  v_not_b32 v111, v110
  v_cmp_eq_u64 vcc, v[112:113], v[110:111]
  v_cmp_ne_u32 s[70:71], 0, v110
  s_and_b64 vcc, vcc, s[70:71]
  s_cmp_eq_u64 vcc, -1
  s_cbranch_scc1 L_vc7
  s_add_u32 s78, s78, 1
  s_cmp_gt_u32 s78, 0x200000
  s_cbranch_scc1 L_vc7
  v_and_b32 v108, 31, v1
  v_lshlrev_b32 v109, 8, v108
  v_lshlrev_b32 v108, 2, v108
  v_lshrrev_b32 v110, 5, v1
  v_lshl_add_u32 v109, v110, 5, v109
  s_lshl_b32 s65, s61, 3
  s_add_u32 s65, s65, 1310720
  v_add_u32 v109, s65, v109
  global_load_dword v110, v108, s[28:29] sc1
  global_load_dwordx2 v[112:113], v109, s[30:31] sc1
  s_waitcnt vmcnt(0)
  s_branch L_vc7a
L_vc7:
  s_waitcnt vmcnt(31)
  v_mfma_f32_16x16x32_bf16 v[32:35], v[128:131], v[20:23], v[32:35]
  global_load_dwordx4 v[128:131], v3, s[34:35] offset:-3072 nt
  s_waitcnt vmcnt(31)
  v_mfma_f32_16x16x32_bf16 v[32:35], v[132:135], v[24:27], v[32:35]
  global_load_dwordx4 v[132:135], v3, s[34:35] offset:-2048 nt
  s_waitcnt vmcnt(31)
  v_mfma_f32_16x16x32_bf16 v[32:35], v[136:139], v[28:31], v[32:35]
  global_load_dwordx4 v[136:139], v3, s[34:35] offset:-1024 nt
  s_waitcnt vmcnt(31)
  v_mfma_f32_16x16x32_bf16 v[36:39], v[140:143], v[16:19], 0
  global_load_dwordx4 v[140:143], v3, s[34:35] offset:0 nt
  s_waitcnt vmcnt(31)
  v_mfma_f32_16x16x32_bf16 v[36:39], v[144:147], v[20:23], v[36:39]
  global_load_dwordx4 v[144:147], v3, s[34:35] offset:1024 nt
  s_waitcnt vmcnt(31)
  v_mfma_f32_16x16x32_bf16 v[36:39], v[148:151], v[24:27], v[36:39]
  global_load_dwordx4 v[148:151], v3, s[34:35] offset:2048 nt
  s_waitcnt vmcnt(31)
  v_mfma_f32_16x16x32_bf16 v[36:39], v[152:155], v[28:31], v[36:39]
  global_load_dwordx4 v[152:155], v3, s[34:35] offset:3072 nt
  s_add_u32 s34, s34, 0x10000
  s_addc_u32 s35, s35, 0
  s_waitcnt vmcnt(31)
  v_mfma_f32_16x16x32_bf16 v[40:43], v[156:159], v[16:19], 0
  global_load_dwordx4 v[156:159], v3, s[34:35] offset:-4096 nt
  s_waitcnt vmcnt(31)
  v_mfma_f32_16x16x32_bf16 v[40:43], v[160:163], v[20:23], v[40:43]
  global_load_dwordx4 v[160:163], v3, s[34:35] offset:-3072 nt
  s_waitcnt vmcnt(31)
  v_mfma_f32_16x16x32_bf16 v[40:43], v[164:167], v[24:27], v[40:43]
  global_load_dwordx4 v[164:167], v3, s[34:35] offset:-2048 nt
  s_waitcnt vmcnt(31)
  v_mfma_f32_16x16x32_bf16 v[40:43], v[168:171], v[28:31], v[40:43]
  global_load_dwordx4 v[168:171], v3, s[34:35] offset:-1024 nt
  s_waitcnt vmcnt(31)
  v_mfma_f32_16x16x32_bf16 v[44:47], v[172:175], v[16:19], 0
  global_load_dwordx4 v[172:175], v3, s[34:35] offset:0 nt
  s_waitcnt vmcnt(31)
  v_mfma_f32_16x16x32_bf16 v[44:47], v[176:179], v[20:23], v[44:47]
  global_load_dwordx4 v[176:179], v3, s[34:35] offset:1024 nt
  s_waitcnt vmcnt(31)
  v_mfma_f32_16x16x32_bf16 v[44:47], v[180:183], v[24:27], v[44:47]
  global_load_dwordx4 v[180:183], v3, s[34:35] offset:2048 nt
  s_waitcnt vmcnt(31)
  v_mfma_f32_16x16x32_bf16 v[44:47], v[184:187], v[28:31], v[44:47]
  global_load_dwordx4 v[184:187], v3, s[34:35] offset:3072 nt
  s_add_u32 s34, s34, 0x10000
  s_addc_u32 s35, s35, 0
  s_nop 7
  v_mov_b32_dpp v76, v32 quad_perm:[0,0,0,0] row_mask:0xf bank_mask:0xf
  v_add_f32_dpp v76, v33, v76 quad_perm:[1,1,1,1] row_mask:0xf bank_mask:0xf
  v_add_f32_dpp v76, v34, v76 quad_perm:[2,2,2,2] row_mask:0xf bank_mask:0xf
  v_add_f32_dpp v76, v35, v76 quad_perm:[3,3,3,3] row_mask:0xf bank_mask:0xf
  v_mov_b32_dpp v77, v36 quad_perm:[0,0,0,0] row_mask:0xf bank_mask:0xf
  v_add_f32_dpp v77, v37, v77 quad_perm:[1,1,1,1] row_mask:0xf bank_mask:0xf
  v_add_f32_dpp v77, v38, v77 quad_perm:[2,2,2,2] row_mask:0xf bank_mask:0xf
  v_add_f32_dpp v77, v39, v77 quad_perm:[3,3,3,3] row_mask:0xf bank_mask:0xf
  v_mov_b32_dpp v78, v40 quad_perm:[0,0,0,0] row_mask:0xf bank_mask:0xf
  v_add_f32_dpp v78, v41, v78 quad_perm:[1,1,1,1] row_mask:0xf bank_mask:0xf
  v_add_f32_dpp v78, v42, v78 quad_perm:[2,2,2,2] row_mask:0xf bank_mask:0xf
  v_add_f32_dpp v78, v43, v78 quad_perm:[3,3,3,3] row_mask:0xf bank_mask:0xf
  v_mov_b32_dpp v79, v44 quad_perm:[0,0,0,0] row_mask:0xf bank_mask:0xf
  v_add_f32_dpp v79, v45, v79 quad_perm:[1,1,1,1] row_mask:0xf bank_mask:0xf
  v_add_f32_dpp v79, v46, v79 quad_perm:[2,2,2,2] row_mask:0xf bank_mask:0xf
  v_add_f32_dpp v79, v47, v79 quad_perm:[3,3,3,3] row_mask:0xf bank_mask:0xf
  v_cndmask_b32 v52, v76, v77, s[44:45]
  v_cndmask_b32 v52, v52, v78, s[46:47]
  v_cndmask_b32 v52, v52, v79, s[48:49]
  v_cvt_pk_bf16_f32 v48, v48, v48
  v_and_b32 v48, 0xffff0000, v48
  v_cvt_pk_bf16_f32 v49, v49, v49
  v_and_b32 v49, 0xffff0000, v49
  v_cvt_pk_bf16_f32 v50, v50, v50
  v_and_b32 v50, 0xffff0000, v50
  v_cvt_pk_bf16_f32 v51, v51, v51
  v_and_b32 v51, 0xffff0000, v51
  v_cvt_pk_bf16_f32 v52, v52, v52
  v_and_b32 v52, 0xffff0000, v52
  v_mul_f32 v48, v48, v13
  v_mul_f32 v49, v49, v13
  v_mul_f32 v50, v50, v13
  v_mul_f32 v51, v51, v13
  v_mul_f32 v52, v52, v13
  v_cvt_pk_bf16_f32 v48, v48, v48
  v_and_b32 v48, 0xffff0000, v48
  v_cvt_pk_bf16_f32 v49, v49, v49
  v_and_b32 v49, 0xffff0000, v49
  v_cvt_pk_bf16_f32 v50, v50, v50
  v_and_b32 v50, 0xffff0000, v50
  v_cvt_pk_bf16_f32 v51, v51, v51
  v_and_b32 v51, 0xffff0000, v51
  v_cvt_pk_bf16_f32 v52, v52, v52
  v_and_b32 v52, 0xffff0000, v52
  v_mul_f32 v48, v48, v12
  v_mul_f32 v49, v49, v12
  v_mul_f32 v50, v50, v12
  v_mul_f32 v51, v51, v12
  v_mul_f32 v52, v52, v12
  v_mov_b32 v76, v48
  v_max_f32 v76, v76, v49
  v_max_f32 v76, v76, v50
  v_max_f32 v76, v76, v51
  v_max_f32 v76, v76, v52
  s_nop 1
  v_max_f32_dpp v76, v76, v76 row_ror:8 row_mask:0xf bank_mask:0xf
  s_nop 1
  v_max_f32_dpp v76, v76, v76 row_ror:4 row_mask:0xf bank_mask:0xf
  s_nop 1
  v_max_f32_dpp v76, v76, v76 row_ror:2 row_mask:0xf bank_mask:0xf
  s_nop 1
  v_max_f32_dpp v76, v76, v76 row_ror:1 row_mask:0xf bank_mask:0xf
  s_nop 1
  v_max_f32_dpp v76, v76, v76 row_bcast:15 row_mask:0xa bank_mask:0xf
  s_nop 1
  v_max_f32_dpp v76, v76, v76 row_bcast:31 row_mask:0xc bank_mask:0xf
  s_nop 0
  v_readlane_b32 s68, v76, 63
  s_nop 1
  v_subrev_f32 v48, s68, v48
  v_subrev_f32 v49, s68, v49
  v_subrev_f32 v50, s68, v50
  v_subrev_f32 v51, s68, v51
  v_subrev_f32 v52, s68, v52
  v_exp_f32 v48, v48
  v_exp_f32 v49, v49
  v_exp_f32 v50, v50
  v_exp_f32 v51, v51
  v_exp_f32 v52, v52
  s_nop 0
  v_cvt_pk_bf16_f32 v53, v48, v48
  v_cvt_pk_bf16_f32 v54, v49, v49
  v_cvt_pk_bf16_f32 v55, v50, v50
  v_cvt_pk_bf16_f32 v56, v51, v51
  v_cvt_pk_bf16_f32 v57, v52, v52
  v_mov_b32 v76, v48
  v_add_f32 v76, v76, v49
  v_add_f32 v76, v76, v50
  v_add_f32 v76, v76, v51
  v_add_f32 v76, v76, v52
  s_nop 1
  v_add_f32_dpp v76, v76, v76 row_ror:8 row_mask:0xf bank_mask:0xf
  s_nop 1
  v_add_f32_dpp v76, v76, v76 row_ror:4 row_mask:0xf bank_mask:0xf
  s_nop 1
  v_add_f32_dpp v76, v76, v76 row_ror:2 row_mask:0xf bank_mask:0xf
  s_nop 1
  v_add_f32_dpp v76, v76, v76 row_ror:1 row_mask:0xf bank_mask:0xf
  s_nop 1
  v_add_f32_dpp v76, v76, v76 row_bcast:15 row_mask:0xa bank_mask:0xf
  s_nop 1
  v_add_f32_dpp v76, v76, v76 row_bcast:31 row_mask:0xc bank_mask:0xf
  s_nop 0
  v_readlane_b32 s69, v76, 63
  s_nop 1
  s_nop 1
  v_and_b32_dpp v60, v53, v6 row_newbcast:0 row_mask:0xf bank_mask:0xf
  v_and_b32_dpp v61, v53, v7 row_newbcast:0 row_mask:0xf bank_mask:0xf
  v_and_b32_dpp v62, v53, v8 row_newbcast:0 row_mask:0xf bank_mask:0xf
  v_and_b32_dpp v63, v53, v9 row_newbcast:0 row_mask:0xf bank_mask:0xf
  v_and_b32_dpp v64, v53, v6 row_newbcast:4 row_mask:0xf bank_mask:0xf
  v_and_b32_dpp v65, v53, v7 row_newbcast:4 row_mask:0xf bank_mask:0xf
  v_and_b32_dpp v66, v53, v8 row_newbcast:4 row_mask:0xf bank_mask:0xf
  v_and_b32_dpp v67, v53, v9 row_newbcast:4 row_mask:0xf bank_mask:0xf
  s_waitcnt vmcnt(31)
  v_mfma_f32_16x16x32_bf16 v[68:71], v[60:63], v[188:191], 0
  global_load_dwordx4 v[188:191], v3, s[34:35] offset:-4096 nt
  v_and_b32_dpp v60, v53, v6 row_newbcast:8 row_mask:0xf bank_mask:0xf
  v_and_b32_dpp v61, v53, v7 row_newbcast:8 row_mask:0xf bank_mask:0xf
  v_and_b32_dpp v62, v53, v8 row_newbcast:8 row_mask:0xf bank_mask:0xf
  v_and_b32_dpp v63, v53, v9 row_newbcast:8 row_mask:0xf bank_mask:0xf
  s_waitcnt vmcnt(31)
  v_mfma_f32_16x16x32_bf16 v[68:71], v[64:67], v[192:195], v[68:71]
  global_load_dwordx4 v[192:195], v3, s[34:35] offset:-3072 nt
  v_and_b32_dpp v64, v53, v6 row_newbcast:12 row_mask:0xf bank_mask:0xf
  v_and_b32_dpp v65, v53, v7 row_newbcast:12 row_mask:0xf bank_mask:0xf
  v_and_b32_dpp v66, v53, v8 row_newbcast:12 row_mask:0xf bank_mask:0xf
  v_and_b32_dpp v67, v53, v9 row_newbcast:12 row_mask:0xf bank_mask:0xf
  s_waitcnt vmcnt(31)
  v_mfma_f32_16x16x32_bf16 v[68:71], v[60:63], v[196:199], v[68:71]
  global_load_dwordx4 v[196:199], v3, s[34:35] offset:-2048 nt
  v_and_b32_dpp v60, v53, v6 row_newbcast:1 row_mask:0xf bank_mask:0xf
  v_and_b32_dpp v61, v53, v7 row_newbcast:1 row_mask:0xf bank_mask:0xf
  v_and_b32_dpp v62, v53, v8 row_newbcast:1 row_mask:0xf bank_mask:0xf
  v_and_b32_dpp v63, v53, v9 row_newbcast:1 row_mask:0xf bank_mask:0xf
  s_waitcnt vmcnt(31)
  v_mfma_f32_16x16x32_bf16 v[68:71], v[64:67], v[200:203], v[68:71]
  global_load_dwordx4 v[200:203], v3, s[34:35] offset:-1024 nt
  v_and_b32_dpp v64, v53, v6 row_newbcast:5 row_mask:0xf bank_mask:0xf
  v_and_b32_dpp v65, v53, v7 row_newbcast:5 row_mask:0xf bank_mask:0xf
  v_and_b32_dpp v66, v53, v8 row_newbcast:5 row_mask:0xf bank_mask:0xf
  v_and_b32_dpp v67, v53, v9 row_newbcast:5 row_mask:0xf bank_mask:0xf
  s_waitcnt vmcnt(31)
  v_mfma_f32_16x16x32_bf16 v[68:71], v[60:63], v[204:207], v[68:71]
  global_load_dwordx4 v[204:207], v3, s[34:35] offset:0 nt
  v_and_b32_dpp v60, v53, v6 row_newbcast:9 row_mask:0xf bank_mask:0xf
  v_and_b32_dpp v61, v53, v7 row_newbcast:9 row_mask:0xf bank_mask:0xf
  v_and_b32_dpp v62, v53, v8 row_newbcast:9 row_mask:0xf bank_mask:0xf
  v_and_b32_dpp v63, v53, v9 row_newbcast:9 row_mask:0xf bank_mask:0xf
  s_waitcnt vmcnt(31)
  v_mfma_f32_16x16x32_bf16 v[68:71], v[64:67], v[208:211], v[68:71]
  global_load_dwordx4 v[208:211], v3, s[34:35] offset:1024 nt
  v_and_b32_dpp v64, v53, v6 row_newbcast:13 row_mask:0xf bank_mask:0xf
  v_and_b32_dpp v65, v53, v7 row_newbcast:13 row_mask:0xf bank_mask:0xf
  v_and_b32_dpp v66, v53, v8 row_newbcast:13 row_mask:0xf bank_mask:0xf
  v_and_b32_dpp v67, v53, v9 row_newbcast:13 row_mask:0xf bank_mask:0xf
  s_waitcnt vmcnt(31)
  v_mfma_f32_16x16x32_bf16 v[68:71], v[60:63], v[212:215], v[68:71]
  global_load_dwordx4 v[212:215], v3, s[34:35] offset:2048 nt
  v_and_b32_dpp v60, v53, v6 row_newbcast:2 row_mask:0xf bank_mask:0xf
  v_and_b32_dpp v61, v53, v7 row_newbcast:2 row_mask:0xf bank_mask:0xf
  v_and_b32_dpp v62, v53, v8 row_newbcast:2 row_mask:0xf bank_mask:0xf
  v_and_b32_dpp v63, v53, v9 row_newbcast:2 row_mask:0xf bank_mask:0xf
  s_waitcnt vmcnt(31)
  v_mfma_f32_16x16x32_bf16 v[68:71], v[64:67], v[216:219], v[68:71]
  global_load_dwordx4 v[216:219], v3, s[34:35] offset:3072 nt
  s_add_u32 s34, s34, 0x10000
  s_addc_u32 s35, s35, 0
  v_and_b32_dpp v64, v53, v6 row_newbcast:6 row_mask:0xf bank_mask:0xf
  v_and_b32_dpp v65, v53, v7 row_newbcast:6 row_mask:0xf bank_mask:0xf
  v_and_b32_dpp v66, v53, v8 row_newbcast:6 row_mask:0xf bank_mask:0xf
  v_and_b32_dpp v67, v53, v9 row_newbcast:6 row_mask:0xf bank_mask:0xf
  s_waitcnt vmcnt(31)
  v_mfma_f32_16x16x32_bf16 v[68:71], v[60:63], v[220:223], v[68:71]
  global_load_dwordx4 v[220:223], v3, s[34:35] offset:-4096 nt
  v_and_b32_dpp v60, v53, v6 row_newbcast:10 row_mask:0xf bank_mask:0xf
  v_and_b32_dpp v61, v53, v7 row_newbcast:10 row_mask:0xf bank_mask:0xf
  v_and_b32_dpp v62, v53, v8 row_newbcast:10 row_mask:0xf bank_mask:0xf
  v_and_b32_dpp v63, v53, v9 row_newbcast:10 row_mask:0xf bank_mask:0xf
  s_waitcnt vmcnt(31)
  v_mfma_f32_16x16x32_bf16 v[68:71], v[64:67], v[224:227], v[68:71]
  global_load_dwordx4 v[224:227], v3, s[34:35] offset:-3072 nt
  v_and_b32_dpp v64, v53, v6 row_newbcast:14 row_mask:0xf bank_mask:0xf
  v_and_b32_dpp v65, v53, v7 row_newbcast:14 row_mask:0xf bank_mask:0xf
  v_and_b32_dpp v66, v53, v8 row_newbcast:14 row_mask:0xf bank_mask:0xf
  v_and_b32_dpp v67, v53, v9 row_newbcast:14 row_mask:0xf bank_mask:0xf
  s_waitcnt vmcnt(31)
  v_mfma_f32_16x16x32_bf16 v[68:71], v[60:63], v[228:231], v[68:71]
  global_load_dwordx4 v[228:231], v3, s[34:35] offset:-2048 nt
  v_and_b32_dpp v60, v53, v6 row_newbcast:3 row_mask:0xf bank_mask:0xf
  v_and_b32_dpp v61, v53, v7 row_newbcast:3 row_mask:0xf bank_mask:0xf
  v_and_b32_dpp v62, v53, v8 row_newbcast:3 row_mask:0xf bank_mask:0xf
  v_and_b32_dpp v63, v53, v9 row_newbcast:3 row_mask:0xf bank_mask:0xf
  s_waitcnt vmcnt(31)
  v_mfma_f32_16x16x32_bf16 v[68:71], v[64:67], v[232:235], v[68:71]
  global_load_dwordx4 v[232:235], v3, s[34:35] offset:-1024 nt
  v_and_b32_dpp v64, v53, v6 row_newbcast:7 row_mask:0xf bank_mask:0xf
  v_and_b32_dpp v65, v53, v7 row_newbcast:7 row_mask:0xf bank_mask:0xf
  v_and_b32_dpp v66, v53, v8 row_newbcast:7 row_mask:0xf bank_mask:0xf
  v_and_b32_dpp v67, v53, v9 row_newbcast:7 row_mask:0xf bank_mask:0xf
  s_waitcnt vmcnt(31)
  v_mfma_f32_16x16x32_bf16 v[68:71], v[60:63], v[236:239], v[68:71]
  global_load_dwordx4 v[236:239], v3, s[34:35] offset:0 nt
  v_and_b32_dpp v60, v53, v6 row_newbcast:11 row_mask:0xf bank_mask:0xf
  v_and_b32_dpp v61, v53, v7 row_newbcast:11 row_mask:0xf bank_mask:0xf
  v_and_b32_dpp v62, v53, v8 row_newbcast:11 row_mask:0xf bank_mask:0xf
  v_and_b32_dpp v63, v53, v9 row_newbcast:11 row_mask:0xf bank_mask:0xf
  s_waitcnt vmcnt(31)
  v_mfma_f32_16x16x32_bf16 v[68:71], v[64:67], v[240:243], v[68:71]
  global_load_dwordx4 v[240:243], v3, s[34:35] offset:1024 nt
  v_and_b32_dpp v64, v53, v6 row_newbcast:15 row_mask:0xf bank_mask:0xf
  v_and_b32_dpp v65, v53, v7 row_newbcast:15 row_mask:0xf bank_mask:0xf
  v_and_b32_dpp v66, v53, v8 row_newbcast:15 row_mask:0xf bank_mask:0xf
  v_and_b32_dpp v67, v53, v9 row_newbcast:15 row_mask:0xf bank_mask:0xf
  s_waitcnt vmcnt(31)
  v_mfma_f32_16x16x32_bf16 v[68:71], v[60:63], v[244:247], v[68:71]
  global_load_dwordx4 v[244:247], v3, s[34:35] offset:2048 nt
  s_nop 0
  s_waitcnt vmcnt(31)
  v_mfma_f32_16x16x32_bf16 v[68:71], v[64:67], v[248:251], v[68:71]
  global_load_dwordx4 v[248:251], v3, s[34:35] offset:3072 nt
  s_add_u32 s34, s34, 0x10000
  s_addc_u32 s35, s35, 0
  s_nop 1
  v_and_b32_dpp v60, v54, v6 row_newbcast:0 row_mask:0xf bank_mask:0xf
  v_and_b32_dpp v61, v54, v7 row_newbcast:0 row_mask:0xf bank_mask:0xf
  v_and_b32_dpp v62, v54, v8 row_newbcast:0 row_mask:0xf bank_mask:0xf
  v_and_b32_dpp v63, v54, v9 row_newbcast:0 row_mask:0xf bank_mask:0xf
  v_and_b32_dpp v64, v54, v6 row_newbcast:4 row_mask:0xf bank_mask:0xf
  v_and_b32_dpp v65, v54, v7 row_newbcast:4 row_mask:0xf bank_mask:0xf
  v_and_b32_dpp v66, v54, v8 row_newbcast:4 row_mask:0xf bank_mask:0xf
  v_and_b32_dpp v67, v54, v9 row_newbcast:4 row_mask:0xf bank_mask:0xf
  s_waitcnt vmcnt(31)
  v_mfma_f32_16x16x32_bf16 v[68:71], v[60:63], v[124:127], v[68:71]
  global_load_dwordx4 v[124:127], v3, s[34:35] offset:-4096 nt
  v_and_b32_dpp v60, v54, v6 row_newbcast:8 row_mask:0xf bank_mask:0xf
  v_and_b32_dpp v61, v54, v7 row_newbcast:8 row_mask:0xf bank_mask:0xf
  v_and_b32_dpp v62, v54, v8 row_newbcast:8 row_mask:0xf bank_mask:0xf
  v_and_b32_dpp v63, v54, v9 row_newbcast:8 row_mask:0xf bank_mask:0xf
  s_waitcnt vmcnt(31)
  v_mfma_f32_16x16x32_bf16 v[68:71], v[64:67], v[128:131], v[68:71]
  global_load_dwordx4 v[128:131], v3, s[34:35] offset:-3072 nt
  v_and_b32_dpp v64, v54, v6 row_newbcast:12 row_mask:0xf bank_mask:0xf
  v_and_b32_dpp v65, v54, v7 row_newbcast:12 row_mask:0xf bank_mask:0xf
  v_and_b32_dpp v66, v54, v8 row_newbcast:12 row_mask:0xf bank_mask:0xf
  v_and_b32_dpp v67, v54, v9 row_newbcast:12 row_mask:0xf bank_mask:0xf
  s_waitcnt vmcnt(31)
  v_mfma_f32_16x16x32_bf16 v[68:71], v[60:63], v[132:135], v[68:71]
  global_load_dwordx4 v[132:135], v3, s[34:35] offset:-2048 nt
  v_and_b32_dpp v60, v54, v6 row_newbcast:1 row_mask:0xf bank_mask:0xf
  v_and_b32_dpp v61, v54, v7 row_newbcast:1 row_mask:0xf bank_mask:0xf
  v_and_b32_dpp v62, v54, v8 row_newbcast:1 row_mask:0xf bank_mask:0xf
  v_and_b32_dpp v63, v54, v9 row_newbcast:1 row_mask:0xf bank_mask:0xf
  s_waitcnt vmcnt(31)
  v_mfma_f32_16x16x32_bf16 v[68:71], v[64:67], v[136:139], v[68:71]
  global_load_dwordx4 v[136:139], v3, s[34:35] offset:-1024 nt
  v_and_b32_dpp v64, v54, v6 row_newbcast:5 row_mask:0xf bank_mask:0xf
  v_and_b32_dpp v65, v54, v7 row_newbcast:5 row_mask:0xf bank_mask:0xf
  v_and_b32_dpp v66, v54, v8 row_newbcast:5 row_mask:0xf bank_mask:0xf
  v_and_b32_dpp v67, v54, v9 row_newbcast:5 row_mask:0xf bank_mask:0xf
  s_waitcnt vmcnt(31)
  v_mfma_f32_16x16x32_bf16 v[68:71], v[60:63], v[140:143], v[68:71]
  global_load_dwordx4 v[140:143], v3, s[34:35] offset:0 nt
  v_and_b32_dpp v60, v54, v6 row_newbcast:9 row_mask:0xf bank_mask:0xf
  v_and_b32_dpp v61, v54, v7 row_newbcast:9 row_mask:0xf bank_mask:0xf
  v_and_b32_dpp v62, v54, v8 row_newbcast:9 row_mask:0xf bank_mask:0xf
  v_and_b32_dpp v63, v54, v9 row_newbcast:9 row_mask:0xf bank_mask:0xf
  s_waitcnt vmcnt(31)
  v_mfma_f32_16x16x32_bf16 v[68:71], v[64:67], v[144:147], v[68:71]
  global_load_dwordx4 v[144:147], v3, s[34:35] offset:1024 nt
  v_and_b32_dpp v64, v54, v6 row_newbcast:13 row_mask:0xf bank_mask:0xf
  v_and_b32_dpp v65, v54, v7 row_newbcast:13 row_mask:0xf bank_mask:0xf
  v_and_b32_dpp v66, v54, v8 row_newbcast:13 row_mask:0xf bank_mask:0xf
  v_and_b32_dpp v67, v54, v9 row_newbcast:13 row_mask:0xf bank_mask:0xf
  s_waitcnt vmcnt(31)
  v_mfma_f32_16x16x32_bf16 v[68:71], v[60:63], v[148:151], v[68:71]
  global_load_dwordx4 v[148:151], v3, s[34:35] offset:2048 nt
  v_and_b32_dpp v60, v54, v6 row_newbcast:2 row_mask:0xf bank_mask:0xf
  v_and_b32_dpp v61, v54, v7 row_newbcast:2 row_mask:0xf bank_mask:0xf
  v_and_b32_dpp v62, v54, v8 row_newbcast:2 row_mask:0xf bank_mask:0xf
  v_and_b32_dpp v63, v54, v9 row_newbcast:2 row_mask:0xf bank_mask:0xf
  s_waitcnt vmcnt(31)
  v_mfma_f32_16x16x32_bf16 v[68:71], v[64:67], v[152:155], v[68:71]
  global_load_dwordx4 v[152:155], v3, s[34:35] offset:3072 nt
  s_add_u32 s34, s34, 0x10000
  s_addc_u32 s35, s35, 0
  v_and_b32_dpp v64, v54, v6 row_newbcast:6 row_mask:0xf bank_mask:0xf
  v_and_b32_dpp v65, v54, v7 row_newbcast:6 row_mask:0xf bank_mask:0xf
  v_and_b32_dpp v66, v54, v8 row_newbcast:6 row_mask:0xf bank_mask:0xf
  v_and_b32_dpp v67, v54, v9 row_newbcast:6 row_mask:0xf bank_mask:0xf
  s_waitcnt vmcnt(31)
  v_mfma_f32_16x16x32_bf16 v[68:71], v[60:63], v[156:159], v[68:71]
  global_load_dwordx4 v[156:159], v3, s[34:35] offset:-4096 nt
  v_and_b32_dpp v60, v54, v6 row_newbcast:10 row_mask:0xf bank_mask:0xf
  v_and_b32_dpp v61, v54, v7 row_newbcast:10 row_mask:0xf bank_mask:0xf
  v_and_b32_dpp v62, v54, v8 row_newbcast:10 row_mask:0xf bank_mask:0xf
  v_and_b32_dpp v63, v54, v9 row_newbcast:10 row_mask:0xf bank_mask:0xf
  s_waitcnt vmcnt(31)
  v_mfma_f32_16x16x32_bf16 v[68:71], v[64:67], v[160:163], v[68:71]
  global_load_dwordx4 v[160:163], v3, s[34:35] offset:-3072 nt
  v_and_b32_dpp v64, v54, v6 row_newbcast:14 row_mask:0xf bank_mask:0xf
  v_and_b32_dpp v65, v54, v7 row_newbcast:14 row_mask:0xf bank_mask:0xf
  v_and_b32_dpp v66, v54, v8 row_newbcast:14 row_mask:0xf bank_mask:0xf
  v_and_b32_dpp v67, v54, v9 row_newbcast:14 row_mask:0xf bank_mask:0xf
  s_waitcnt vmcnt(31)
  v_mfma_f32_16x16x32_bf16 v[68:71], v[60:63], v[164:167], v[68:71]
  global_load_dwordx4 v[164:167], v3, s[34:35] offset:-2048 nt
  v_and_b32_dpp v60, v54, v6 row_newbcast:3 row_mask:0xf bank_mask:0xf
  v_and_b32_dpp v61, v54, v7 row_newbcast:3 row_mask:0xf bank_mask:0xf
  v_and_b32_dpp v62, v54, v8 row_newbcast:3 row_mask:0xf bank_mask:0xf
  v_and_b32_dpp v63, v54, v9 row_newbcast:3 row_mask:0xf bank_mask:0xf
  s_waitcnt vmcnt(31)
  v_mfma_f32_16x16x32_bf16 v[68:71], v[64:67], v[168:171], v[68:71]
  global_load_dwordx4 v[168:171], v3, s[34:35] offset:-1024 nt
  v_and_b32_dpp v64, v54, v6 row_newbcast:7 row_mask:0xf bank_mask:0xf
  v_and_b32_dpp v65, v54, v7 row_newbcast:7 row_mask:0xf bank_mask:0xf
  v_and_b32_dpp v66, v54, v8 row_newbcast:7 row_mask:0xf bank_mask:0xf
  v_and_b32_dpp v67, v54, v9 row_newbcast:7 row_mask:0xf bank_mask:0xf
  s_waitcnt vmcnt(31)
  v_mfma_f32_16x16x32_bf16 v[68:71], v[60:63], v[172:175], v[68:71]
  global_load_dwordx4 v[172:175], v3, s[34:35] offset:0 nt
  v_and_b32_dpp v60, v54, v6 row_newbcast:11 row_mask:0xf bank_mask:0xf
  v_and_b32_dpp v61, v54, v7 row_newbcast:11 row_mask:0xf bank_mask:0xf
  v_and_b32_dpp v62, v54, v8 row_newbcast:11 row_mask:0xf bank_mask:0xf
  v_and_b32_dpp v63, v54, v9 row_newbcast:11 row_mask:0xf bank_mask:0xf
  s_waitcnt vmcnt(31)
  v_mfma_f32_16x16x32_bf16 v[68:71], v[64:67], v[176:179], v[68:71]
  global_load_dwordx4 v[176:179], v3, s[34:35] offset:1024 nt
  v_and_b32_dpp v64, v54, v6 row_newbcast:15 row_mask:0xf bank_mask:0xf
  v_and_b32_dpp v65, v54, v7 row_newbcast:15 row_mask:0xf bank_mask:0xf
  v_and_b32_dpp v66, v54, v8 row_newbcast:15 row_mask:0xf bank_mask:0xf
  v_and_b32_dpp v67, v54, v9 row_newbcast:15 row_mask:0xf bank_mask:0xf
  s_waitcnt vmcnt(31)
  v_mfma_f32_16x16x32_bf16 v[68:71], v[60:63], v[180:183], v[68:71]
  global_load_dwordx4 v[180:183], v3, s[34:35] offset:2048 nt
  s_nop 0
  s_waitcnt vmcnt(31)
  v_mfma_f32_16x16x32_bf16 v[68:71], v[64:67], v[184:187], v[68:71]
  global_load_dwordx4 v[184:187], v3, s[34:35] offset:3072 nt
  s_add_u32 s34, s34, 0x10000
  s_addc_u32 s35, s35, 0
  s_nop 1
  v_and_b32_dpp v60, v55, v6 row_newbcast:0 row_mask:0xf bank_mask:0xf
  v_and_b32_dpp v61, v55, v7 row_newbcast:0 row_mask:0xf bank_mask:0xf
  v_and_b32_dpp v62, v55, v8 row_newbcast:0 row_mask:0xf bank_mask:0xf
  v_and_b32_dpp v63, v55, v9 row_newbcast:0 row_mask:0xf bank_mask:0xf
  v_and_b32_dpp v64, v55, v6 row_newbcast:4 row_mask:0xf bank_mask:0xf
  v_and_b32_dpp v65, v55, v7 row_newbcast:4 row_mask:0xf bank_mask:0xf
  v_and_b32_dpp v66, v55, v8 row_newbcast:4 row_mask:0xf bank_mask:0xf
  v_and_b32_dpp v67, v55, v9 row_newbcast:4 row_mask:0xf bank_mask:0xf
  s_waitcnt vmcnt(31)
  v_mfma_f32_16x16x32_bf16 v[68:71], v[60:63], v[188:191], v[68:71]
  global_load_dwordx4 v[188:191], v3, s[34:35] offset:-4096 nt
  s_cmp_lg_u32 s3, 0
  s_cbranch_scc1 L_pi8
  s_lshl_b32 s65, s63, 8
  s_add_u32 s65, s65, 1376256
  v_mov_b32 v100, s65
  global_load_dwordx2 v[102:103], v100, s[30:31] sc1
L_pi8:
  v_and_b32_dpp v60, v55, v6 row_newbcast:8 row_mask:0xf bank_mask:0xf
  v_and_b32_dpp v61, v55, v7 row_newbcast:8 row_mask:0xf bank_mask:0xf
  v_and_b32_dpp v62, v55, v8 row_newbcast:8 row_mask:0xf bank_mask:0xf
  v_and_b32_dpp v63, v55, v9 row_newbcast:8 row_mask:0xf bank_mask:0xf
  s_waitcnt vmcnt(31)
  v_mfma_f32_16x16x32_bf16 v[68:71], v[64:67], v[192:195], v[68:71]
  global_load_dwordx4 v[192:195], v3, s[34:35] offset:-3072 nt
  v_and_b32_dpp v64, v55, v6 row_newbcast:12 row_mask:0xf bank_mask:0xf
  v_and_b32_dpp v65, v55, v7 row_newbcast:12 row_mask:0xf bank_mask:0xf
  v_and_b32_dpp v66, v55, v8 row_newbcast:12 row_mask:0xf bank_mask:0xf
  v_and_b32_dpp v67, v55, v9 row_newbcast:12 row_mask:0xf bank_mask:0xf
  s_waitcnt vmcnt(31)
  v_mfma_f32_16x16x32_bf16 v[68:71], v[60:63], v[196:199], v[68:71]
  global_load_dwordx4 v[196:199], v3, s[34:35] offset:-2048 nt
  v_and_b32_dpp v60, v55, v6 row_newbcast:1 row_mask:0xf bank_mask:0xf
  v_and_b32_dpp v61, v55, v7 row_newbcast:1 row_mask:0xf bank_mask:0xf
  v_and_b32_dpp v62, v55, v8 row_newbcast:1 row_mask:0xf bank_mask:0xf
  v_and_b32_dpp v63, v55, v9 row_newbcast:1 row_mask:0xf bank_mask:0xf
  s_waitcnt vmcnt(31)
  v_mfma_f32_16x16x32_bf16 v[68:71], v[64:67], v[200:203], v[68:71]
  global_load_dwordx4 v[200:203], v3, s[34:35] offset:-1024 nt
  v_and_b32_dpp v64, v55, v6 row_newbcast:5 row_mask:0xf bank_mask:0xf
  v_and_b32_dpp v65, v55, v7 row_newbcast:5 row_mask:0xf bank_mask:0xf
  v_and_b32_dpp v66, v55, v8 row_newbcast:5 row_mask:0xf bank_mask:0xf
  v_and_b32_dpp v67, v55, v9 row_newbcast:5 row_mask:0xf bank_mask:0xf
  s_waitcnt vmcnt(31)
  v_mfma_f32_16x16x32_bf16 v[68:71], v[60:63], v[204:207], v[68:71]
  global_load_dwordx4 v[204:207], v3, s[34:35] offset:0 nt
  v_and_b32_dpp v60, v55, v6 row_newbcast:9 row_mask:0xf bank_mask:0xf
  v_and_b32_dpp v61, v55, v7 row_newbcast:9 row_mask:0xf bank_mask:0xf
  v_and_b32_dpp v62, v55, v8 row_newbcast:9 row_mask:0xf bank_mask:0xf
  v_and_b32_dpp v63, v55, v9 row_newbcast:9 row_mask:0xf bank_mask:0xf
  s_waitcnt vmcnt(31)
  v_mfma_f32_16x16x32_bf16 v[68:71], v[64:67], v[208:211], v[68:71]
  global_load_dwordx4 v[208:211], v3, s[34:35] offset:1024 nt
  v_and_b32_dpp v64, v55, v6 row_newbcast:13 row_mask:0xf bank_mask:0xf
  v_and_b32_dpp v65, v55, v7 row_newbcast:13 row_mask:0xf bank_mask:0xf
  v_and_b32_dpp v66, v55, v8 row_newbcast:13 row_mask:0xf bank_mask:0xf
  v_and_b32_dpp v67, v55, v9 row_newbcast:13 row_mask:0xf bank_mask:0xf
  s_waitcnt vmcnt(31)
  v_mfma_f32_16x16x32_bf16 v[68:71], v[60:63], v[212:215], v[68:71]
  global_load_dwordx4 v[212:215], v3, s[34:35] offset:2048 nt
  v_and_b32_dpp v60, v55, v6 row_newbcast:2 row_mask:0xf bank_mask:0xf
  v_and_b32_dpp v61, v55, v7 row_newbcast:2 row_mask:0xf bank_mask:0xf
  v_and_b32_dpp v62, v55, v8 row_newbcast:2 row_mask:0xf bank_mask:0xf
  v_and_b32_dpp v63, v55, v9 row_newbcast:2 row_mask:0xf bank_mask:0xf
  s_waitcnt vmcnt(31)
  v_mfma_f32_16x16x32_bf16 v[68:71], v[64:67], v[216:219], v[68:71]
  global_load_dwordx4 v[216:219], v3, s[34:35] offset:3072 nt
  s_add_u32 s34, s34, 0x10000
  s_addc_u32 s35, s35, 0
  v_and_b32_dpp v64, v55, v6 row_newbcast:6 row_mask:0xf bank_mask:0xf
  v_and_b32_dpp v65, v55, v7 row_newbcast:6 row_mask:0xf bank_mask:0xf
  v_and_b32_dpp v66, v55, v8 row_newbcast:6 row_mask:0xf bank_mask:0xf
  v_and_b32_dpp v67, v55, v9 row_newbcast:6 row_mask:0xf bank_mask:0xf
  s_waitcnt vmcnt(31)
  v_mfma_f32_16x16x32_bf16 v[68:71], v[60:63], v[220:223], v[68:71]
  global_load_dwordx4 v[220:223], v3, s[34:35] offset:-4096 nt
  v_and_b32_dpp v60, v55, v6 row_newbcast:10 row_mask:0xf bank_mask:0xf
  v_and_b32_dpp v61, v55, v7 row_newbcast:10 row_mask:0xf bank_mask:0xf
  v_and_b32_dpp v62, v55, v8 row_newbcast:10 row_mask:0xf bank_mask:0xf
  v_and_b32_dpp v63, v55, v9 row_newbcast:10 row_mask:0xf bank_mask:0xf
  s_waitcnt vmcnt(31)
  v_mfma_f32_16x16x32_bf16 v[68:71], v[64:67], v[224:227], v[68:71]
  global_load_dwordx4 v[224:227], v3, s[34:35] offset:-3072 nt
  v_and_b32_dpp v64, v55, v6 row_newbcast:14 row_mask:0xf bank_mask:0xf
  v_and_b32_dpp v65, v55, v7 row_newbcast:14 row_mask:0xf bank_mask:0xf
  v_and_b32_dpp v66, v55, v8 row_newbcast:14 row_mask:0xf bank_mask:0xf
  v_and_b32_dpp v67, v55, v9 row_newbcast:14 row_mask:0xf bank_mask:0xf
  s_waitcnt vmcnt(31)
  v_mfma_f32_16x16x32_bf16 v[68:71], v[60:63], v[228:231], v[68:71]
  global_load_dwordx4 v[228:231], v3, s[34:35] offset:-2048 nt
  v_and_b32_dpp v60, v55, v6 row_newbcast:3 row_mask:0xf bank_mask:0xf
  v_and_b32_dpp v61, v55, v7 row_newbcast:3 row_mask:0xf bank_mask:0xf
  v_and_b32_dpp v62, v55, v8 row_newbcast:3 row_mask:0xf bank_mask:0xf
  v_and_b32_dpp v63, v55, v9 row_newbcast:3 row_mask:0xf bank_mask:0xf
  s_waitcnt vmcnt(31)
  v_mfma_f32_16x16x32_bf16 v[68:71], v[64:67], v[232:235], v[68:71]
  global_load_dwordx4 v[232:235], v3, s[34:35] offset:-1024 nt
  v_and_b32_dpp v64, v55, v6 row_newbcast:7 row_mask:0xf bank_mask:0xf
  v_and_b32_dpp v65, v55, v7 row_newbcast:7 row_mask:0xf bank_mask:0xf
  v_and_b32_dpp v66, v55, v8 row_newbcast:7 row_mask:0xf bank_mask:0xf
  v_and_b32_dpp v67, v55, v9 row_newbcast:7 row_mask:0xf bank_mask:0xf
  s_waitcnt vmcnt(31)
  v_mfma_f32_16x16x32_bf16 v[68:71], v[60:63], v[236:239], v[68:71]
  global_load_dwordx4 v[236:239], v3, s[34:35] offset:0 nt
  v_and_b32_dpp v60, v55, v6 row_newbcast:11 row_mask:0xf bank_mask:0xf
  v_and_b32_dpp v61, v55, v7 row_newbcast:11 row_mask:0xf bank_mask:0xf
  v_and_b32_dpp v62, v55, v8 row_newbcast:11 row_mask:0xf bank_mask:0xf
  v_and_b32_dpp v63, v55, v9 row_newbcast:11 row_mask:0xf bank_mask:0xf
  s_waitcnt vmcnt(31)
  v_mfma_f32_16x16x32_bf16 v[68:71], v[64:67], v[240:243], v[68:71]
  global_load_dwordx4 v[240:243], v3, s[34:35] offset:1024 nt
  v_and_b32_dpp v64, v55, v6 row_newbcast:15 row_mask:0xf bank_mask:0xf
  v_and_b32_dpp v65, v55, v7 row_newbcast:15 row_mask:0xf bank_mask:0xf
  v_and_b32_dpp v66, v55, v8 row_newbcast:15 row_mask:0xf bank_mask:0xf
  v_and_b32_dpp v67, v55, v9 row_newbcast:15 row_mask:0xf bank_mask:0xf
  s_waitcnt vmcnt(31)
  v_mfma_f32_16x16x32_bf16 v[68:71], v[60:63], v[244:247], v[68:71]
  global_load_dwordx4 v[244:247], v3, s[34:35] offset:2048 nt
  s_nop 0
  s_waitcnt vmcnt(31)
  v_mfma_f32_16x16x32_bf16 v[68:71], v[64:67], v[248:251], v[68:71]
  global_load_dwordx4 v[248:251], v3, s[34:35] offset:3072 nt
  s_add_u32 s34, s34, 0x10000
  s_addc_u32 s35, s35, 0
  s_nop 1
  v_and_b32_dpp v60, v56, v6 row_newbcast:0 row_mask:0xf bank_mask:0xf
  v_and_b32_dpp v61, v56, v7 row_newbcast:0 row_mask:0xf bank_mask:0xf
  v_and_b32_dpp v62, v56, v8 row_newbcast:0 row_mask:0xf bank_mask:0xf
  v_and_b32_dpp v63, v56, v9 row_newbcast:0 row_mask:0xf bank_mask:0xf
  v_and_b32_dpp v64, v56, v6 row_newbcast:4 row_mask:0xf bank_mask:0xf
  v_and_b32_dpp v65, v56, v7 row_newbcast:4 row_mask:0xf bank_mask:0xf
  v_and_b32_dpp v66, v56, v8 row_newbcast:4 row_mask:0xf bank_mask:0xf
  v_and_b32_dpp v67, v56, v9 row_newbcast:4 row_mask:0xf bank_mask:0xf
  s_waitcnt vmcnt(31)
  v_mfma_f32_16x16x32_bf16 v[68:71], v[60:63], v[124:127], v[68:71]
  v_and_b32_dpp v60, v56, v6 row_newbcast:8 row_mask:0xf bank_mask:0xf
  v_and_b32_dpp v61, v56, v7 row_newbcast:8 row_mask:0xf bank_mask:0xf
  v_and_b32_dpp v62, v56, v8 row_newbcast:8 row_mask:0xf bank_mask:0xf
  v_and_b32_dpp v63, v56, v9 row_newbcast:8 row_mask:0xf bank_mask:0xf
  s_waitcnt vmcnt(30)
  v_mfma_f32_16x16x32_bf16 v[68:71], v[64:67], v[128:131], v[68:71]
  v_and_b32_dpp v64, v56, v6 row_newbcast:12 row_mask:0xf bank_mask:0xf
  v_and_b32_dpp v65, v56, v7 row_newbcast:12 row_mask:0xf bank_mask:0xf
  v_and_b32_dpp v66, v56, v8 row_newbcast:12 row_mask:0xf bank_mask:0xf
  v_and_b32_dpp v67, v56, v9 row_newbcast:12 row_mask:0xf bank_mask:0xf
  s_waitcnt vmcnt(29)
  v_mfma_f32_16x16x32_bf16 v[68:71], v[60:63], v[132:135], v[68:71]
  v_and_b32_dpp v60, v56, v6 row_newbcast:1 row_mask:0xf bank_mask:0xf
  v_and_b32_dpp v61, v56, v7 row_newbcast:1 row_mask:0xf bank_mask:0xf
  v_and_b32_dpp v62, v56, v8 row_newbcast:1 row_mask:0xf bank_mask:0xf
  v_and_b32_dpp v63, v56, v9 row_newbcast:1 row_mask:0xf bank_mask:0xf
  s_waitcnt vmcnt(28)
  v_mfma_f32_16x16x32_bf16 v[68:71], v[64:67], v[136:139], v[68:71]
  v_and_b32_dpp v64, v56, v6 row_newbcast:5 row_mask:0xf bank_mask:0xf
  v_and_b32_dpp v65, v56, v7 row_newbcast:5 row_mask:0xf bank_mask:0xf
  v_and_b32_dpp v66, v56, v8 row_newbcast:5 row_mask:0xf bank_mask:0xf
  v_and_b32_dpp v67, v56, v9 row_newbcast:5 row_mask:0xf bank_mask:0xf
  s_waitcnt vmcnt(27)
  v_mfma_f32_16x16x32_bf16 v[68:71], v[60:63], v[140:143], v[68:71]
  v_and_b32_dpp v60, v56, v6 row_newbcast:9 row_mask:0xf bank_mask:0xf
  v_and_b32_dpp v61, v56, v7 row_newbcast:9 row_mask:0xf bank_mask:0xf
  v_and_b32_dpp v62, v56, v8 row_newbcast:9 row_mask:0xf bank_mask:0xf
  v_and_b32_dpp v63, v56, v9 row_newbcast:9 row_mask:0xf bank_mask:0xf
  s_waitcnt vmcnt(26)
  v_mfma_f32_16x16x32_bf16 v[68:71], v[64:67], v[144:147], v[68:71]
  v_and_b32_dpp v64, v56, v6 row_newbcast:13 row_mask:0xf bank_mask:0xf
  v_and_b32_dpp v65, v56, v7 row_newbcast:13 row_mask:0xf bank_mask:0xf
  v_and_b32_dpp v66, v56, v8 row_newbcast:13 row_mask:0xf bank_mask:0xf
  v_and_b32_dpp v67, v56, v9 row_newbcast:13 row_mask:0xf bank_mask:0xf
  s_waitcnt vmcnt(25)
  v_mfma_f32_16x16x32_bf16 v[68:71], v[60:63], v[148:151], v[68:71]
  v_and_b32_dpp v60, v56, v6 row_newbcast:2 row_mask:0xf bank_mask:0xf
  v_and_b32_dpp v61, v56, v7 row_newbcast:2 row_mask:0xf bank_mask:0xf
  v_and_b32_dpp v62, v56, v8 row_newbcast:2 row_mask:0xf bank_mask:0xf
  v_and_b32_dpp v63, v56, v9 row_newbcast:2 row_mask:0xf bank_mask:0xf
  s_waitcnt vmcnt(24)
  v_mfma_f32_16x16x32_bf16 v[68:71], v[64:67], v[152:155], v[68:71]
  v_and_b32_dpp v64, v56, v6 row_newbcast:6 row_mask:0xf bank_mask:0xf
  v_and_b32_dpp v65, v56, v7 row_newbcast:6 row_mask:0xf bank_mask:0xf
  v_and_b32_dpp v66, v56, v8 row_newbcast:6 row_mask:0xf bank_mask:0xf
  v_and_b32_dpp v67, v56, v9 row_newbcast:6 row_mask:0xf bank_mask:0xf
  s_waitcnt vmcnt(23)
  v_mfma_f32_16x16x32_bf16 v[68:71], v[60:63], v[156:159], v[68:71]
  v_and_b32_dpp v60, v56, v6 row_newbcast:10 row_mask:0xf bank_mask:0xf
  v_and_b32_dpp v61, v56, v7 row_newbcast:10 row_mask:0xf bank_mask:0xf
  v_and_b32_dpp v62, v56, v8 row_newbcast:10 row_mask:0xf bank_mask:0xf
  v_and_b32_dpp v63, v56, v9 row_newbcast:10 row_mask:0xf bank_mask:0xf
  s_waitcnt vmcnt(22)
  v_mfma_f32_16x16x32_bf16 v[68:71], v[64:67], v[160:163], v[68:71]
  v_and_b32_dpp v64, v56, v6 row_newbcast:14 row_mask:0xf bank_mask:0xf
  v_and_b32_dpp v65, v56, v7 row_newbcast:14 row_mask:0xf bank_mask:0xf
  v_and_b32_dpp v66, v56, v8 row_newbcast:14 row_mask:0xf bank_mask:0xf
  v_and_b32_dpp v67, v56, v9 row_newbcast:14 row_mask:0xf bank_mask:0xf
  s_waitcnt vmcnt(21)
  v_mfma_f32_16x16x32_bf16 v[68:71], v[60:63], v[164:167], v[68:71]
  v_and_b32_dpp v60, v56, v6 row_newbcast:3 row_mask:0xf bank_mask:0xf
  v_and_b32_dpp v61, v56, v7 row_newbcast:3 row_mask:0xf bank_mask:0xf
  v_and_b32_dpp v62, v56, v8 row_newbcast:3 row_mask:0xf bank_mask:0xf
  v_and_b32_dpp v63, v56, v9 row_newbcast:3 row_mask:0xf bank_mask:0xf
  s_waitcnt vmcnt(20)
  v_mfma_f32_16x16x32_bf16 v[68:71], v[64:67], v[168:171], v[68:71]
  v_and_b32_dpp v64, v56, v6 row_newbcast:7 row_mask:0xf bank_mask:0xf
  v_and_b32_dpp v65, v56, v7 row_newbcast:7 row_mask:0xf bank_mask:0xf
  v_and_b32_dpp v66, v56, v8 row_newbcast:7 row_mask:0xf bank_mask:0xf
  v_and_b32_dpp v67, v56, v9 row_newbcast:7 row_mask:0xf bank_mask:0xf
  s_waitcnt vmcnt(19)
  v_mfma_f32_16x16x32_bf16 v[68:71], v[60:63], v[172:175], v[68:71]
  v_and_b32_dpp v60, v56, v6 row_newbcast:11 row_mask:0xf bank_mask:0xf
  v_and_b32_dpp v61, v56, v7 row_newbcast:11 row_mask:0xf bank_mask:0xf
  v_and_b32_dpp v62, v56, v8 row_newbcast:11 row_mask:0xf bank_mask:0xf
  v_and_b32_dpp v63, v56, v9 row_newbcast:11 row_mask:0xf bank_mask:0xf
  s_waitcnt vmcnt(18)
  v_mfma_f32_16x16x32_bf16 v[68:71], v[64:67], v[176:179], v[68:71]
  v_and_b32_dpp v64, v56, v6 row_newbcast:15 row_mask:0xf bank_mask:0xf
  v_and_b32_dpp v65, v56, v7 row_newbcast:15 row_mask:0xf bank_mask:0xf
  v_and_b32_dpp v66, v56, v8 row_newbcast:15 row_mask:0xf bank_mask:0xf
  v_and_b32_dpp v67, v56, v9 row_newbcast:15 row_mask:0xf bank_mask:0xf
  s_waitcnt vmcnt(17)
  v_mfma_f32_16x16x32_bf16 v[68:71], v[60:63], v[180:183], v[68:71]
  s_nop 0
  s_waitcnt vmcnt(16)
  v_mfma_f32_16x16x32_bf16 v[68:71], v[64:67], v[184:187], v[68:71]
  s_nop 1
  v_and_b32_dpp v60, v57, v6 row_newbcast:0 row_mask:0xf bank_mask:0xf
  v_and_b32_dpp v61, v57, v7 row_newbcast:0 row_mask:0xf bank_mask:0xf
  v_and_b32_dpp v62, v57, v8 row_newbcast:0 row_mask:0xf bank_mask:0xf
  v_and_b32_dpp v63, v57, v9 row_newbcast:0 row_mask:0xf bank_mask:0xf
  v_and_b32_dpp v64, v57, v6 row_newbcast:4 row_mask:0xf bank_mask:0xf
  v_and_b32_dpp v65, v57, v7 row_newbcast:4 row_mask:0xf bank_mask:0xf
  v_and_b32_dpp v66, v57, v8 row_newbcast:4 row_mask:0xf bank_mask:0xf
  v_and_b32_dpp v67, v57, v9 row_newbcast:4 row_mask:0xf bank_mask:0xf
  s_waitcnt vmcnt(15)
  v_mfma_f32_16x16x32_bf16 v[68:71], v[60:63], v[188:191], v[68:71]
  s_cmp_lg_u32 s3, 0
  s_cbranch_scc1 L_pc9
  s_lshl_b32 s65, s63, 8
  s_add_u32 s65, s65, 1376256
  v_mov_b32 v100, s65
  s_mov_b32 s78, 0
  s_not_b32 s66, s79
L_pc9a:
  v_readfirstlane_b32 s64, v102
  v_readfirstlane_b32 s65, v103
  s_xor_b32 s64, s64, s79
  s_xor_b32 s65, s65, s66
  s_or_b32 s64, s64, s65
  s_cbranch_scc0 L_pc9b
  s_add_u32 s78, s78, 1
  s_cmp_gt_u32 s78, 0x200000
  s_cbranch_scc1 L_pc9b
  global_load_dwordx2 v[102:103], v100, s[30:31] sc1
  s_waitcnt vmcnt(0)
  s_branch L_pc9a
L_pc9b:
  s_lshl_b32 s64, s63, 10
  s_add_u32 s64, s64, 1048576
  v_add_u32 v100, s64, v3
  global_load_dwordx4 v[104:107], v100, s[30:31] sc1
L_pc9:
  v_and_b32_dpp v60, v57, v6 row_newbcast:8 row_mask:0xf bank_mask:0xf
  v_and_b32_dpp v61, v57, v7 row_newbcast:8 row_mask:0xf bank_mask:0xf
  v_and_b32_dpp v62, v57, v8 row_newbcast:8 row_mask:0xf bank_mask:0xf
  v_and_b32_dpp v63, v57, v9 row_newbcast:8 row_mask:0xf bank_mask:0xf
  s_waitcnt vmcnt(14)
  v_mfma_f32_16x16x32_bf16 v[68:71], v[64:67], v[192:195], v[68:71]
  s_lshl_b32 s64, s3, 14
  v_add_u32 v14, s64, v3
  ds_read_b128 v[188:191], v14 offset:0
  v_and_b32_dpp v64, v57, v6 row_newbcast:12 row_mask:0xf bank_mask:0xf
  v_and_b32_dpp v65, v57, v7 row_newbcast:12 row_mask:0xf bank_mask:0xf
  v_and_b32_dpp v66, v57, v8 row_newbcast:12 row_mask:0xf bank_mask:0xf
  v_and_b32_dpp v67, v57, v9 row_newbcast:12 row_mask:0xf bank_mask:0xf
  s_waitcnt vmcnt(13)
  v_mfma_f32_16x16x32_bf16 v[68:71], v[60:63], v[196:199], v[68:71]
  ds_read_b128 v[192:195], v14 offset:1024
  v_and_b32_dpp v60, v57, v6 row_newbcast:1 row_mask:0xf bank_mask:0xf
  v_and_b32_dpp v61, v57, v7 row_newbcast:1 row_mask:0xf bank_mask:0xf
  v_and_b32_dpp v62, v57, v8 row_newbcast:1 row_mask:0xf bank_mask:0xf
  v_and_b32_dpp v63, v57, v9 row_newbcast:1 row_mask:0xf bank_mask:0xf
  s_waitcnt vmcnt(12)
  v_mfma_f32_16x16x32_bf16 v[68:71], v[64:67], v[200:203], v[68:71]
  ds_read_b128 v[196:199], v14 offset:2048
  v_and_b32_dpp v64, v57, v6 row_newbcast:5 row_mask:0xf bank_mask:0xf
  v_and_b32_dpp v65, v57, v7 row_newbcast:5 row_mask:0xf bank_mask:0xf
  v_and_b32_dpp v66, v57, v8 row_newbcast:5 row_mask:0xf bank_mask:0xf
  v_and_b32_dpp v67, v57, v9 row_newbcast:5 row_mask:0xf bank_mask:0xf
  s_waitcnt vmcnt(11)
  v_mfma_f32_16x16x32_bf16 v[68:71], v[60:63], v[204:207], v[68:71]
  ds_read_b128 v[200:203], v14 offset:3072
  v_and_b32_dpp v60, v57, v6 row_newbcast:9 row_mask:0xf bank_mask:0xf
  v_and_b32_dpp v61, v57, v7 row_newbcast:9 row_mask:0xf bank_mask:0xf
  v_and_b32_dpp v62, v57, v8 row_newbcast:9 row_mask:0xf bank_mask:0xf
  v_and_b32_dpp v63, v57, v9 row_newbcast:9 row_mask:0xf bank_mask:0xf
  s_waitcnt vmcnt(10)
  v_mfma_f32_16x16x32_bf16 v[68:71], v[64:67], v[208:211], v[68:71]
  ds_read_b128 v[204:207], v14 offset:4096
  v_and_b32_dpp v64, v57, v6 row_newbcast:13 row_mask:0xf bank_mask:0xf
  v_and_b32_dpp v65, v57, v7 row_newbcast:13 row_mask:0xf bank_mask:0xf
  v_and_b32_dpp v66, v57, v8 row_newbcast:13 row_mask:0xf bank_mask:0xf
  v_and_b32_dpp v67, v57, v9 row_newbcast:13 row_mask:0xf bank_mask:0xf
  s_waitcnt vmcnt(9)
  v_mfma_f32_16x16x32_bf16 v[68:71], v[60:63], v[212:215], v[68:71]
  ds_read_b128 v[208:211], v14 offset:5120
  v_and_b32_dpp v60, v57, v6 row_newbcast:2 row_mask:0xf bank_mask:0xf
  v_and_b32_dpp v61, v57, v7 row_newbcast:2 row_mask:0xf bank_mask:0xf
  v_and_b32_dpp v62, v57, v8 row_newbcast:2 row_mask:0xf bank_mask:0xf
  v_and_b32_dpp v63, v57, v9 row_newbcast:2 row_mask:0xf bank_mask:0xf
  s_waitcnt vmcnt(8)
  v_mfma_f32_16x16x32_bf16 v[68:71], v[64:67], v[216:219], v[68:71]
  ds_read_b128 v[212:215], v14 offset:6144
  v_and_b32_dpp v64, v57, v6 row_newbcast:6 row_mask:0xf bank_mask:0xf
  v_and_b32_dpp v65, v57, v7 row_newbcast:6 row_mask:0xf bank_mask:0xf
  v_and_b32_dpp v66, v57, v8 row_newbcast:6 row_mask:0xf bank_mask:0xf
  v_and_b32_dpp v67, v57, v9 row_newbcast:6 row_mask:0xf bank_mask:0xf
  s_waitcnt vmcnt(7)
  v_mfma_f32_16x16x32_bf16 v[68:71], v[60:63], v[220:223], v[68:71]
  ds_read_b128 v[216:219], v14 offset:7168
  v_and_b32_dpp v60, v57, v6 row_newbcast:10 row_mask:0xf bank_mask:0xf
  v_and_b32_dpp v61, v57, v7 row_newbcast:10 row_mask:0xf bank_mask:0xf
  v_and_b32_dpp v62, v57, v8 row_newbcast:10 row_mask:0xf bank_mask:0xf
  v_and_b32_dpp v63, v57, v9 row_newbcast:10 row_mask:0xf bank_mask:0xf
  s_waitcnt vmcnt(6)
  v_mfma_f32_16x16x32_bf16 v[68:71], v[64:67], v[224:227], v[68:71]
  ds_read_b128 v[220:223], v14 offset:8192
  v_and_b32_dpp v64, v57, v6 row_newbcast:14 row_mask:0xf bank_mask:0xf
  v_and_b32_dpp v65, v57, v7 row_newbcast:14 row_mask:0xf bank_mask:0xf
  v_and_b32_dpp v66, v57, v8 row_newbcast:14 row_mask:0xf bank_mask:0xf
  v_and_b32_dpp v67, v57, v9 row_newbcast:14 row_mask:0xf bank_mask:0xf
  s_waitcnt vmcnt(5)
  v_mfma_f32_16x16x32_bf16 v[68:71], v[60:63], v[228:231], v[68:71]
  ds_read_b128 v[224:227], v14 offset:9216
  v_and_b32_dpp v60, v57, v6 row_newbcast:3 row_mask:0xf bank_mask:0xf
  v_and_b32_dpp v61, v57, v7 row_newbcast:3 row_mask:0xf bank_mask:0xf
  v_and_b32_dpp v62, v57, v8 row_newbcast:3 row_mask:0xf bank_mask:0xf
  v_and_b32_dpp v63, v57, v9 row_newbcast:3 row_mask:0xf bank_mask:0xf
  s_waitcnt vmcnt(4)
  v_mfma_f32_16x16x32_bf16 v[68:71], v[64:67], v[232:235], v[68:71]
  ds_read_b128 v[228:231], v14 offset:10240
  v_and_b32_dpp v64, v57, v6 row_newbcast:7 row_mask:0xf bank_mask:0xf
  v_and_b32_dpp v65, v57, v7 row_newbcast:7 row_mask:0xf bank_mask:0xf
  v_and_b32_dpp v66, v57, v8 row_newbcast:7 row_mask:0xf bank_mask:0xf
  v_and_b32_dpp v67, v57, v9 row_newbcast:7 row_mask:0xf bank_mask:0xf
  s_waitcnt vmcnt(3)
  v_mfma_f32_16x16x32_bf16 v[68:71], v[60:63], v[236:239], v[68:71]
  ds_read_b128 v[232:235], v14 offset:11264
  v_and_b32_dpp v60, v57, v6 row_newbcast:11 row_mask:0xf bank_mask:0xf
  v_and_b32_dpp v61, v57, v7 row_newbcast:11 row_mask:0xf bank_mask:0xf
  v_and_b32_dpp v62, v57, v8 row_newbcast:11 row_mask:0xf bank_mask:0xf
  v_and_b32_dpp v63, v57, v9 row_newbcast:11 row_mask:0xf bank_mask:0xf
  s_waitcnt vmcnt(2)
  v_mfma_f32_16x16x32_bf16 v[68:71], v[64:67], v[240:243], v[68:71]
  ds_read_b128 v[236:239], v14 offset:12288
  v_and_b32_dpp v64, v57, v6 row_newbcast:15 row_mask:0xf bank_mask:0xf
  v_and_b32_dpp v65, v57, v7 row_newbcast:15 row_mask:0xf bank_mask:0xf
  v_and_b32_dpp v66, v57, v8 row_newbcast:15 row_mask:0xf bank_mask:0xf
  v_and_b32_dpp v67, v57, v9 row_newbcast:15 row_mask:0xf bank_mask:0xf
  s_waitcnt vmcnt(1)
  v_mfma_f32_16x16x32_bf16 v[68:71], v[60:63], v[244:247], v[68:71]
  ds_read_b128 v[240:243], v14 offset:13312
  s_nop 0
  s_waitcnt vmcnt(0)
  v_mfma_f32_16x16x32_bf16 v[68:71], v[64:67], v[248:251], v[68:71]
  ds_read_b128 v[244:247], v14 offset:14336
  v_and_b32 v76, 1, v11
  v_lshlrev_b32 v76, 4, v76
  v_lshl_add_u32 v76, v10, 5, v76
  s_lshl_b32 s64, s3, 9
  s_add_u32 s64, s64, 152704
  v_add_u32 v76, s64, v76
  s_lshl_b32 s64, s3, 3
  s_add_u32 s64, s64, 157312
  v_mov_b32 v77, s64
  v_mov_b32 v78, s68
  v_mov_b32 v79, s69
  ds_write_b64 v77, v[78:79]
  s_nop 3
  ds_write_b128 v76, v[68:71]
  s_cmp_lg_u32 s3, 0
  s_cbranch_scc1 L_px10
  s_waitcnt vmcnt(0)
  v_add_u32 v100, 156800, v3
  s_mov_b32 exec_hi, 0
  ds_write_b128 v100, v[104:107]
  s_mov_b32 exec_lo, 0
  s_mov_b32 exec_hi, 1
  v_mov_b32 v100, 157376
  ds_write_b64 v100, v[104:105]
  s_mov_b64 exec, -1
L_px10:
  s_waitcnt lgkmcnt(0)
  s_barrier
  v_mov_b32 v114, 157312
  ds_read_b128 v[76:79], v114 offset:0
  ds_read_b128 v[80:83], v114 offset:16
  ds_read_b128 v[84:87], v114 offset:32
  ds_read_b128 v[88:91], v114 offset:48
  ds_read_b128 v[92:95], v114 offset:64
  v_lshl_add_u32 v115, v10, 3, v11
  v_lshlrev_b32 v115, 2, v115
  v_add_u32 v115, 152704, v115
  ds_read_b32 v96, v115 offset:0
  ds_read_b32 v97, v115 offset:16
  ds_read_b32 v98, v115 offset:512
  ds_read_b32 v99, v115 offset:528
  ds_read_b32 v100, v115 offset:1024
  ds_read_b32 v101, v115 offset:1040
  ds_read_b32 v102, v115 offset:1536
  ds_read_b32 v103, v115 offset:1552
  ds_read_b32 v104, v115 offset:2048
  ds_read_b32 v105, v115 offset:2064
  ds_read_b32 v106, v115 offset:2560
  ds_read_b32 v107, v115 offset:2576
  ds_read_b32 v108, v115 offset:3072
  ds_read_b32 v109, v115 offset:3088
  ds_read_b32 v110, v115 offset:3584
  ds_read_b32 v111, v115 offset:3600
  ds_read_b32 v112, v115 offset:4096
  ds_read_b32 v113, v115 offset:4112
  s_waitcnt lgkmcnt(0)
  v_max_f32 v117, v76, v78
  v_max_f32 v117, v117, v80
  v_max_f32 v117, v117, v82
  v_max_f32 v117, v117, v84
  v_max_f32 v117, v117, v86
  v_max_f32 v117, v117, v88
  v_max_f32 v117, v117, v90
  v_max_f32 v117, v117, v92
  v_sub_f32 v76, v76, v117
  v_sub_f32 v78, v78, v117
  v_sub_f32 v80, v80, v117
  v_sub_f32 v82, v82, v117
  v_sub_f32 v84, v84, v117
  v_sub_f32 v86, v86, v117
  v_sub_f32 v88, v88, v117
  v_sub_f32 v90, v90, v117
  v_sub_f32 v92, v92, v117
  v_exp_f32 v76, v76
  v_exp_f32 v78, v78
  v_exp_f32 v80, v80
  v_exp_f32 v82, v82
  v_exp_f32 v84, v84
  v_exp_f32 v86, v86
  v_exp_f32 v88, v88
  v_exp_f32 v90, v90
  v_exp_f32 v92, v92
  s_nop 0
  v_mul_f32 v118, v76, v77
  v_fmac_f32 v118, v78, v79
  v_fmac_f32 v118, v80, v81
  v_fmac_f32 v118, v82, v83
  v_fmac_f32 v118, v84, v85
  v_fmac_f32 v118, v86, v87
  v_fmac_f32 v118, v88, v89
  v_fmac_f32 v118, v90, v91
  v_fmac_f32 v118, v92, v93
  v_rcp_f32 v114, v118
  v_mul_f32 v115, v76, v96
  v_mul_f32 v116, v76, v97
  v_fmac_f32 v115, v78, v98
  v_fmac_f32 v116, v78, v99
  v_fmac_f32 v115, v80, v100
  v_fmac_f32 v116, v80, v101
  v_fmac_f32 v115, v82, v102
  v_fmac_f32 v116, v82, v103
  v_fmac_f32 v115, v84, v104
  v_fmac_f32 v116, v84, v105
  v_fmac_f32 v115, v86, v106
  v_fmac_f32 v116, v86, v107
  v_fmac_f32 v115, v88, v108
  v_fmac_f32 v116, v88, v109
  v_fmac_f32 v115, v90, v110
  v_fmac_f32 v116, v90, v111
  v_fmac_f32 v115, v92, v112
  v_fmac_f32 v116, v92, v113
  v_mul_f32 v115, v115, v114
  v_mul_f32 v116, v116, v114
  s_branch L_tail
L_pathS:
  s_waitcnt vmcnt(31)
  v_mfma_f32_16x16x32_bf16 v[32:35], v[124:127], v[16:19], 0
  global_load_dwordx4 v[124:127], v2, s[32:33] offset:-4096 nt
  s_lshl_b32 s64, s3, 14
  s_add_u32 m0, s64, 0
  s_nop 0
  global_load_lds_dwordx4 v5, s[42:43] nt
  s_add_u32 s42, s42, 0x2000
  s_addc_u32 s43, s43, 0
  s_waitcnt vmcnt(32)
  v_mfma_f32_16x16x32_bf16 v[32:35], v[128:131], v[20:23], v[32:35]
  global_load_dwordx4 v[128:131], v2, s[32:33] offset:-3072 nt
  s_lshl_b32 s64, s3, 14
  s_add_u32 m0, s64, 1024
  s_nop 0
  global_load_lds_dwordx4 v5, s[42:43] nt
  s_add_u32 s42, s42, 0x2000
  s_addc_u32 s43, s43, 0
  s_waitcnt vmcnt(33)
  v_mfma_f32_16x16x32_bf16 v[32:35], v[132:135], v[24:27], v[32:35]
  global_load_dwordx4 v[132:135], v2, s[32:33] offset:-2048 nt
  s_lshl_b32 s64, s3, 14
  s_add_u32 m0, s64, 2048
  s_nop 0
  global_load_lds_dwordx4 v5, s[42:43] nt
  s_add_u32 s42, s42, 0x2000
  s_addc_u32 s43, s43, 0
  s_waitcnt vmcnt(34)
  v_mfma_f32_16x16x32_bf16 v[32:35], v[136:139], v[28:31], v[32:35]
  global_load_dwordx4 v[136:139], v2, s[32:33] offset:-1024 nt
  s_lshl_b32 s64, s3, 14
  s_add_u32 m0, s64, 3072
  s_nop 0
  global_load_lds_dwordx4 v5, s[42:43] nt
  s_add_u32 s42, s42, 0x2000
  s_addc_u32 s43, s43, 0
  s_waitcnt vmcnt(35)
  v_mfma_f32_16x16x32_bf16 v[36:39], v[140:143], v[16:19], 0
  global_load_dwordx4 v[140:143], v2, s[32:33] offset:0 nt
  s_lshl_b32 s64, s3, 14
  s_add_u32 m0, s64, 4096
  s_nop 0
  global_load_lds_dwordx4 v5, s[42:43] nt
  s_add_u32 s42, s42, 0x2000
  s_addc_u32 s43, s43, 0
  s_waitcnt vmcnt(36)
  v_mfma_f32_16x16x32_bf16 v[36:39], v[144:147], v[20:23], v[36:39]
  global_load_dwordx4 v[144:147], v2, s[32:33] offset:1024 nt
  s_lshl_b32 s64, s3, 14
  s_add_u32 m0, s64, 5120
  s_nop 0
  global_load_lds_dwordx4 v5, s[42:43] nt
  s_add_u32 s42, s42, 0x2000
  s_addc_u32 s43, s43, 0
  s_waitcnt vmcnt(37)
  v_mfma_f32_16x16x32_bf16 v[36:39], v[148:151], v[24:27], v[36:39]
  global_load_dwordx4 v[148:151], v2, s[32:33] offset:2048 nt
  s_lshl_b32 s64, s3, 14
  s_add_u32 m0, s64, 6144
  s_nop 0
  global_load_lds_dwordx4 v5, s[42:43] nt
  s_add_u32 s42, s42, 0x2000
  s_addc_u32 s43, s43, 0
  s_waitcnt vmcnt(38)
  v_mfma_f32_16x16x32_bf16 v[36:39], v[152:155], v[28:31], v[36:39]
  global_load_dwordx4 v[152:155], v2, s[32:33] offset:3072 nt
  s_add_u32 s32, s32, 0x10000
  s_addc_u32 s33, s33, 0
  s_lshl_b32 s64, s3, 14
  s_add_u32 m0, s64, 7168
  s_nop 0
  global_load_lds_dwordx4 v5, s[42:43] nt
  s_add_u32 s42, s42, 0x2000
  s_addc_u32 s43, s43, 0
  s_waitcnt vmcnt(39)
  v_mfma_f32_16x16x32_bf16 v[40:43], v[156:159], v[16:19], 0
  global_load_dwordx4 v[156:159], v2, s[32:33] offset:-4096 nt
  s_lshl_b32 s64, s3, 14
  s_add_u32 m0, s64, 8192
  s_nop 0
  global_load_lds_dwordx4 v5, s[42:43] nt
  s_add_u32 s42, s42, 0x2000
  s_addc_u32 s43, s43, 0
  s_waitcnt vmcnt(40)
  v_mfma_f32_16x16x32_bf16 v[40:43], v[160:163], v[20:23], v[40:43]
  global_load_dwordx4 v[160:163], v2, s[32:33] offset:-3072 nt
  s_lshl_b32 s64, s3, 14
  s_add_u32 m0, s64, 9216
  s_nop 0
  global_load_lds_dwordx4 v5, s[42:43] nt
  s_add_u32 s42, s42, 0x2000
  s_addc_u32 s43, s43, 0
  s_waitcnt vmcnt(41)
  v_mfma_f32_16x16x32_bf16 v[40:43], v[164:167], v[24:27], v[40:43]
  global_load_dwordx4 v[164:167], v2, s[32:33] offset:-2048 nt
  s_lshl_b32 s64, s3, 14
  s_add_u32 m0, s64, 10240
  s_nop 0
  global_load_lds_dwordx4 v5, s[42:43] nt
  s_add_u32 s42, s42, 0x2000
  s_addc_u32 s43, s43, 0
  s_waitcnt vmcnt(42)
  v_mfma_f32_16x16x32_bf16 v[40:43], v[168:171], v[28:31], v[40:43]
  global_load_dwordx4 v[168:171], v2, s[32:33] offset:-1024 nt
  s_lshl_b32 s64, s3, 14
  s_add_u32 m0, s64, 11264
  s_nop 0
  global_load_lds_dwordx4 v5, s[42:43] nt
  s_add_u32 s42, s42, 0x2000
  s_addc_u32 s43, s43, 0
  s_waitcnt vmcnt(43)
  v_mfma_f32_16x16x32_bf16 v[44:47], v[172:175], v[16:19], 0
  global_load_dwordx4 v[172:175], v2, s[32:33] offset:0 nt
  s_lshl_b32 s64, s3, 14
  s_add_u32 m0, s64, 12288
  s_nop 0
  global_load_lds_dwordx4 v5, s[42:43] nt
  s_add_u32 s42, s42, 0x2000
  s_addc_u32 s43, s43, 0
  s_waitcnt vmcnt(44)
  v_mfma_f32_16x16x32_bf16 v[44:47], v[176:179], v[20:23], v[44:47]
  global_load_dwordx4 v[176:179], v2, s[32:33] offset:1024 nt
  s_lshl_b32 s64, s3, 14
  s_add_u32 m0, s64, 13312
  s_nop 0
  global_load_lds_dwordx4 v5, s[42:43] nt
  s_add_u32 s42, s42, 0x2000
  s_addc_u32 s43, s43, 0
  s_waitcnt vmcnt(45)
  v_mfma_f32_16x16x32_bf16 v[44:47], v[180:183], v[24:27], v[44:47]
  global_load_dwordx4 v[180:183], v2, s[32:33] offset:2048 nt
  s_lshl_b32 s64, s3, 14
  s_add_u32 m0, s64, 14336
  s_nop 0
  global_load_lds_dwordx4 v5, s[42:43] nt
  s_add_u32 s42, s42, 0x2000
  s_addc_u32 s43, s43, 0
  s_waitcnt vmcnt(46)
  v_mfma_f32_16x16x32_bf16 v[44:47], v[184:187], v[28:31], v[44:47]
  global_load_dwordx4 v[184:187], v2, s[32:33] offset:3072 nt
  s_add_u32 s32, s32, 0x10000
  s_addc_u32 s33, s33, 0
  s_lshl_b32 s64, s3, 14
  s_add_u32 m0, s64, 15360
  s_nop 0
  global_load_lds_dwordx4 v5, s[42:43] nt
  s_nop 7
  v_mov_b32_dpp v76, v32 quad_perm:[0,0,0,0] row_mask:0xf bank_mask:0xf
  v_add_f32_dpp v76, v33, v76 quad_perm:[1,1,1,1] row_mask:0xf bank_mask:0xf
  v_add_f32_dpp v76, v34, v76 quad_perm:[2,2,2,2] row_mask:0xf bank_mask:0xf
  v_add_f32_dpp v76, v35, v76 quad_perm:[3,3,3,3] row_mask:0xf bank_mask:0xf
  v_mov_b32_dpp v77, v36 quad_perm:[0,0,0,0] row_mask:0xf bank_mask:0xf
  v_add_f32_dpp v77, v37, v77 quad_perm:[1,1,1,1] row_mask:0xf bank_mask:0xf
  v_add_f32_dpp v77, v38, v77 quad_perm:[2,2,2,2] row_mask:0xf bank_mask:0xf
  v_add_f32_dpp v77, v39, v77 quad_perm:[3,3,3,3] row_mask:0xf bank_mask:0xf
  v_mov_b32_dpp v78, v40 quad_perm:[0,0,0,0] row_mask:0xf bank_mask:0xf
  v_add_f32_dpp v78, v41, v78 quad_perm:[1,1,1,1] row_mask:0xf bank_mask:0xf
  v_add_f32_dpp v78, v42, v78 quad_perm:[2,2,2,2] row_mask:0xf bank_mask:0xf
  v_add_f32_dpp v78, v43, v78 quad_perm:[3,3,3,3] row_mask:0xf bank_mask:0xf
  v_mov_b32_dpp v79, v44 quad_perm:[0,0,0,0] row_mask:0xf bank_mask:0xf
  v_add_f32_dpp v79, v45, v79 quad_perm:[1,1,1,1] row_mask:0xf bank_mask:0xf
  v_add_f32_dpp v79, v46, v79 quad_perm:[2,2,2,2] row_mask:0xf bank_mask:0xf
  v_add_f32_dpp v79, v47, v79 quad_perm:[3,3,3,3] row_mask:0xf bank_mask:0xf
  v_cndmask_b32 v48, v76, v77, s[44:45]
  v_cndmask_b32 v48, v48, v78, s[46:47]
  v_cndmask_b32 v48, v48, v79, s[48:49]
  s_lshl_b32 s64, s61, 10
  v_add_u32 v14, s64, v3
  global_load_dwordx4 v[84:87], v14, s[8:9]
  global_load_dwordx4 v[88:91], v3, s[4:5]
  s_waitcnt vmcnt(49)
  v_mfma_f32_16x16x32_bf16 v[32:35], v[188:191], v[16:19], 0
  global_load_dwordx4 v[188:191], v3, s[34:35] offset:-4096 nt
  s_waitcnt vmcnt(49)
  v_mfma_f32_16x16x32_bf16 v[32:35], v[192:195], v[20:23], v[32:35]
  global_load_dwordx4 v[192:195], v3, s[34:35] offset:-3072 nt
  s_waitcnt vmcnt(49)
  v_mfma_f32_16x16x32_bf16 v[32:35], v[196:199], v[24:27], v[32:35]
  global_load_dwordx4 v[196:199], v3, s[34:35] offset:-2048 nt
  s_waitcnt vmcnt(49)
  v_mfma_f32_16x16x32_bf16 v[32:35], v[200:203], v[28:31], v[32:35]
  global_load_dwordx4 v[200:203], v3, s[34:35] offset:-1024 nt
  s_waitcnt vmcnt(49)
  v_mfma_f32_16x16x32_bf16 v[36:39], v[204:207], v[16:19], 0
  global_load_dwordx4 v[204:207], v3, s[34:35] offset:0 nt
  s_waitcnt vmcnt(49)
  v_mfma_f32_16x16x32_bf16 v[36:39], v[208:211], v[20:23], v[36:39]
  global_load_dwordx4 v[208:211], v3, s[34:35] offset:1024 nt
  s_waitcnt vmcnt(49)
  v_mfma_f32_16x16x32_bf16 v[36:39], v[212:215], v[24:27], v[36:39]
  global_load_dwordx4 v[212:215], v3, s[34:35] offset:2048 nt
  s_waitcnt vmcnt(49)
  v_mfma_f32_16x16x32_bf16 v[36:39], v[216:219], v[28:31], v[36:39]
  global_load_dwordx4 v[216:219], v3, s[34:35] offset:3072 nt
  s_add_u32 s34, s34, 0x10000
  s_addc_u32 s35, s35, 0
  s_waitcnt vmcnt(49)
  v_mfma_f32_16x16x32_bf16 v[40:43], v[220:223], v[16:19], 0
  global_load_dwordx4 v[220:223], v3, s[34:35] offset:-4096 nt
  s_waitcnt vmcnt(49)
  v_mfma_f32_16x16x32_bf16 v[40:43], v[224:227], v[20:23], v[40:43]
  global_load_dwordx4 v[224:227], v3, s[34:35] offset:-3072 nt
  s_waitcnt vmcnt(49)
  v_mfma_f32_16x16x32_bf16 v[40:43], v[228:231], v[24:27], v[40:43]
  global_load_dwordx4 v[228:231], v3, s[34:35] offset:-2048 nt
  s_waitcnt vmcnt(49)
  v_mfma_f32_16x16x32_bf16 v[40:43], v[232:235], v[28:31], v[40:43]
  global_load_dwordx4 v[232:235], v3, s[34:35] offset:-1024 nt
  s_waitcnt vmcnt(49)
  v_mfma_f32_16x16x32_bf16 v[44:47], v[236:239], v[16:19], 0
  global_load_dwordx4 v[236:239], v3, s[34:35] offset:0 nt
  s_waitcnt vmcnt(49)
  v_mfma_f32_16x16x32_bf16 v[44:47], v[240:243], v[20:23], v[44:47]
  global_load_dwordx4 v[240:243], v3, s[34:35] offset:1024 nt
  s_waitcnt vmcnt(49)
  v_mfma_f32_16x16x32_bf16 v[44:47], v[244:247], v[24:27], v[44:47]
  global_load_dwordx4 v[244:247], v3, s[34:35] offset:2048 nt
  s_waitcnt vmcnt(49)
  v_mfma_f32_16x16x32_bf16 v[44:47], v[248:251], v[28:31], v[44:47]
  global_load_dwordx4 v[248:251], v3, s[34:35] offset:3072 nt
  s_add_u32 s34, s34, 0x10000
  s_addc_u32 s35, s35, 0
  s_nop 7
  v_mov_b32_dpp v76, v32 quad_perm:[0,0,0,0] row_mask:0xf bank_mask:0xf
  v_add_f32_dpp v76, v33, v76 quad_perm:[1,1,1,1] row_mask:0xf bank_mask:0xf
  v_add_f32_dpp v76, v34, v76 quad_perm:[2,2,2,2] row_mask:0xf bank_mask:0xf
  v_add_f32_dpp v76, v35, v76 quad_perm:[3,3,3,3] row_mask:0xf bank_mask:0xf
  v_mov_b32_dpp v77, v36 quad_perm:[0,0,0,0] row_mask:0xf bank_mask:0xf
  v_add_f32_dpp v77, v37, v77 quad_perm:[1,1,1,1] row_mask:0xf bank_mask:0xf
  v_add_f32_dpp v77, v38, v77 quad_perm:[2,2,2,2] row_mask:0xf bank_mask:0xf
  v_add_f32_dpp v77, v39, v77 quad_perm:[3,3,3,3] row_mask:0xf bank_mask:0xf
  v_mov_b32_dpp v78, v40 quad_perm:[0,0,0,0] row_mask:0xf bank_mask:0xf
  v_add_f32_dpp v78, v41, v78 quad_perm:[1,1,1,1] row_mask:0xf bank_mask:0xf
  v_add_f32_dpp v78, v42, v78 quad_perm:[2,2,2,2] row_mask:0xf bank_mask:0xf
  v_add_f32_dpp v78, v43, v78 quad_perm:[3,3,3,3] row_mask:0xf bank_mask:0xf
  v_mov_b32_dpp v79, v44 quad_perm:[0,0,0,0] row_mask:0xf bank_mask:0xf
  v_add_f32_dpp v79, v45, v79 quad_perm:[1,1,1,1] row_mask:0xf bank_mask:0xf
  v_add_f32_dpp v79, v46, v79 quad_perm:[2,2,2,2] row_mask:0xf bank_mask:0xf
  v_add_f32_dpp v79, v47, v79 quad_perm:[3,3,3,3] row_mask:0xf bank_mask:0xf
  v_cndmask_b32 v49, v76, v77, s[44:45]
  v_cndmask_b32 v49, v49, v78, s[46:47]
  v_cndmask_b32 v49, v49, v79, s[48:49]
  s_waitcnt vmcnt(49)
  v_mfma_f32_16x16x32_bf16 v[32:35], v[124:127], v[16:19], 0
  global_load_dwordx4 v[124:127], v3, s[34:35] offset:-4096 nt
  s_waitcnt vmcnt(48)
  v_mfma_f32_16x16x32_bf16 v[32:35], v[128:131], v[20:23], v[32:35]
  global_load_dwordx4 v[128:131], v3, s[34:35] offset:-3072 nt
  s_waitcnt vmcnt(47)
  v_mfma_f32_16x16x32_bf16 v[32:35], v[132:135], v[24:27], v[32:35]
  global_load_dwordx4 v[132:135], v3, s[34:35] offset:-2048 nt
  s_waitcnt vmcnt(46)
  v_mfma_f32_16x16x32_bf16 v[32:35], v[136:139], v[28:31], v[32:35]
  global_load_dwordx4 v[136:139], v3, s[34:35] offset:-1024 nt
  s_waitcnt vmcnt(45)
  v_mfma_f32_16x16x32_bf16 v[36:39], v[140:143], v[16:19], 0
  global_load_dwordx4 v[140:143], v3, s[34:35] offset:0 nt
  s_waitcnt vmcnt(44)
  v_mfma_f32_16x16x32_bf16 v[36:39], v[144:147], v[20:23], v[36:39]
  global_load_dwordx4 v[144:147], v3, s[34:35] offset:1024 nt
  s_waitcnt vmcnt(43)
  v_mfma_f32_16x16x32_bf16 v[36:39], v[148:151], v[24:27], v[36:39]
  global_load_dwordx4 v[148:151], v3, s[34:35] offset:2048 nt
  s_waitcnt vmcnt(42)
  v_mfma_f32_16x16x32_bf16 v[36:39], v[152:155], v[28:31], v[36:39]
  global_load_dwordx4 v[152:155], v3, s[34:35] offset:3072 nt
  s_add_u32 s34, s34, 0x10000
  s_addc_u32 s35, s35, 0
  s_waitcnt vmcnt(41)
  v_mfma_f32_16x16x32_bf16 v[40:43], v[156:159], v[16:19], 0
  global_load_dwordx4 v[156:159], v3, s[34:35] offset:-4096 nt
  s_waitcnt vmcnt(40)
  v_mfma_f32_16x16x32_bf16 v[40:43], v[160:163], v[20:23], v[40:43]
  global_load_dwordx4 v[160:163], v3, s[34:35] offset:-3072 nt
  s_waitcnt vmcnt(39)
  v_mfma_f32_16x16x32_bf16 v[40:43], v[164:167], v[24:27], v[40:43]
  global_load_dwordx4 v[164:167], v3, s[34:35] offset:-2048 nt
  s_waitcnt vmcnt(38)
  v_mfma_f32_16x16x32_bf16 v[40:43], v[168:171], v[28:31], v[40:43]
  global_load_dwordx4 v[168:171], v3, s[34:35] offset:-1024 nt
  s_waitcnt vmcnt(37)
  v_mfma_f32_16x16x32_bf16 v[44:47], v[172:175], v[16:19], 0
  global_load_dwordx4 v[172:175], v3, s[34:35] offset:0 nt
  s_waitcnt vmcnt(36)
  v_mfma_f32_16x16x32_bf16 v[44:47], v[176:179], v[20:23], v[44:47]
  global_load_dwordx4 v[176:179], v3, s[34:35] offset:1024 nt
  s_waitcnt vmcnt(35)
  v_mfma_f32_16x16x32_bf16 v[44:47], v[180:183], v[24:27], v[44:47]
  global_load_dwordx4 v[180:183], v3, s[34:35] offset:2048 nt
  s_waitcnt vmcnt(34)
  v_mfma_f32_16x16x32_bf16 v[44:47], v[184:187], v[28:31], v[44:47]
  global_load_dwordx4 v[184:187], v3, s[34:35] offset:3072 nt
  s_add_u32 s34, s34, 0x10000
  s_addc_u32 s35, s35, 0
  s_nop 7
  v_mov_b32_dpp v76, v32 quad_perm:[0,0,0,0] row_mask:0xf bank_mask:0xf
  v_add_f32_dpp v76, v33, v76 quad_perm:[1,1,1,1] row_mask:0xf bank_mask:0xf
  v_add_f32_dpp v76, v34, v76 quad_perm:[2,2,2,2] row_mask:0xf bank_mask:0xf
  v_add_f32_dpp v76, v35, v76 quad_perm:[3,3,3,3] row_mask:0xf bank_mask:0xf
  v_mov_b32_dpp v77, v36 quad_perm:[0,0,0,0] row_mask:0xf bank_mask:0xf
  v_add_f32_dpp v77, v37, v77 quad_perm:[1,1,1,1] row_mask:0xf bank_mask:0xf
  v_add_f32_dpp v77, v38, v77 quad_perm:[2,2,2,2] row_mask:0xf bank_mask:0xf
  v_add_f32_dpp v77, v39, v77 quad_perm:[3,3,3,3] row_mask:0xf bank_mask:0xf
  v_mov_b32_dpp v78, v40 quad_perm:[0,0,0,0] row_mask:0xf bank_mask:0xf
  v_add_f32_dpp v78, v41, v78 quad_perm:[1,1,1,1] row_mask:0xf bank_mask:0xf
  v_add_f32_dpp v78, v42, v78 quad_perm:[2,2,2,2] row_mask:0xf bank_mask:0xf
  v_add_f32_dpp v78, v43, v78 quad_perm:[3,3,3,3] row_mask:0xf bank_mask:0xf
  v_mov_b32_dpp v79, v44 quad_perm:[0,0,0,0] row_mask:0xf bank_mask:0xf
  v_add_f32_dpp v79, v45, v79 quad_perm:[1,1,1,1] row_mask:0xf bank_mask:0xf
  v_add_f32_dpp v79, v46, v79 quad_perm:[2,2,2,2] row_mask:0xf bank_mask:0xf
  v_add_f32_dpp v79, v47, v79 quad_perm:[3,3,3,3] row_mask:0xf bank_mask:0xf
  v_cndmask_b32 v50, v76, v77, s[44:45]
  v_cndmask_b32 v50, v50, v78, s[46:47]
  v_cndmask_b32 v50, v50, v79, s[48:49]
  s_waitcnt vmcnt(32)
  v_mov_b32 v81, 0
  v_lshlrev_b32 v76, 16, v84
  v_lshlrev_b32 v77, 16, v88
  v_mul_f32 v76, v76, v77
  v_and_b32 v78, 0xffff0000, v84
  v_and_b32 v79, 0xffff0000, v88
  v_mul_f32 v78, v78, v79
  v_cvt_pk_bf16_f32 v76, v76, v78
  v_lshlrev_b32 v77, 16, v76
  v_and_b32 v78, 0xffff0000, v76
  v_add_f32 v81, v81, v77
  v_add_f32 v81, v81, v78
  v_lshlrev_b32 v76, 16, v85
  v_lshlrev_b32 v77, 16, v89
  v_mul_f32 v76, v76, v77
  v_and_b32 v78, 0xffff0000, v85
  v_and_b32 v79, 0xffff0000, v89
  v_mul_f32 v78, v78, v79
  v_cvt_pk_bf16_f32 v76, v76, v78
  v_lshlrev_b32 v77, 16, v76
  v_and_b32 v78, 0xffff0000, v76
  v_add_f32 v81, v81, v77
  v_add_f32 v81, v81, v78
  v_lshlrev_b32 v76, 16, v86
  v_lshlrev_b32 v77, 16, v90
  v_mul_f32 v76, v76, v77
  v_and_b32 v78, 0xffff0000, v86
  v_and_b32 v79, 0xffff0000, v90
  v_mul_f32 v78, v78, v79
  v_cvt_pk_bf16_f32 v76, v76, v78
  v_lshlrev_b32 v77, 16, v76
  v_and_b32 v78, 0xffff0000, v76
  v_add_f32 v81, v81, v77
  v_add_f32 v81, v81, v78
  v_lshlrev_b32 v76, 16, v87
  v_lshlrev_b32 v77, 16, v91
  v_mul_f32 v76, v76, v77
  v_and_b32 v78, 0xffff0000, v87
  v_and_b32 v79, 0xffff0000, v91
  v_mul_f32 v78, v78, v79
  v_cvt_pk_bf16_f32 v76, v76, v78
  v_lshlrev_b32 v77, 16, v76
  v_and_b32 v78, 0xffff0000, v76
  v_add_f32 v81, v81, v77
  v_add_f32 v81, v81, v78
  s_nop 1
  v_add_f32_dpp v81, v81, v81 row_ror:8 row_mask:0xf bank_mask:0xf
  s_nop 1
  v_add_f32_dpp v81, v81, v81 row_ror:4 row_mask:0xf bank_mask:0xf
  s_nop 1
  v_add_f32_dpp v81, v81, v81 row_ror:2 row_mask:0xf bank_mask:0xf
  s_nop 1
  v_add_f32_dpp v81, v81, v81 row_ror:1 row_mask:0xf bank_mask:0xf
  s_nop 1
  v_add_f32_dpp v81, v81, v81 row_bcast:15 row_mask:0xa bank_mask:0xf
  s_nop 1
  v_add_f32_dpp v81, v81, v81 row_bcast:31 row_mask:0xc bank_mask:0xf
  s_nop 0
  v_readlane_b32 s64, v81, 63
  s_nop 1
  v_mov_b32 v15, s64
  v_cvt_pk_bf16_f32 v15, v15, v15
  v_and_b32 v15, 0xffff0000, v15
  v_mul_f32 v15, v12, v15
  v_exp_f32 v15, -v15
  s_nop 0
  v_add_f32 v15, 1.0, v15
  v_rcp_f32 v15, v15
  s_nop 0
  v_cvt_pk_bf16_f32 v15, v15, v15
  v_and_b32 v15, 0xffff0000, v15
  v_sub_f32 v0, 1.0, v15
  v_cvt_pk_bf16_f32 v0, v0, v0
  v_and_b32 v0, 0xffff0000, v0
  v_cvt_pk_bf16_f32 v48, v48, v48
  v_and_b32 v48, 0xffff0000, v48
  v_cvt_pk_bf16_f32 v49, v49, v49
  v_and_b32 v49, 0xffff0000, v49
  v_cvt_pk_bf16_f32 v50, v50, v50
  v_and_b32 v50, 0xffff0000, v50
  v_mul_f32 v48, v48, v13
  v_mul_f32 v49, v49, v13
  v_mul_f32 v50, v50, v13
  v_cvt_pk_bf16_f32 v48, v48, v48
  v_and_b32 v48, 0xffff0000, v48
  v_cvt_pk_bf16_f32 v49, v49, v49
  v_and_b32 v49, 0xffff0000, v49
  v_cvt_pk_bf16_f32 v50, v50, v50
  v_and_b32 v50, 0xffff0000, v50
  v_mul_f32 v48, v48, v12
  v_mul_f32 v49, v49, v12
  v_mul_f32 v50, v50, v12
  v_mov_b32 v76, v48
  v_max_f32 v76, v76, v49
  v_max_f32 v76, v76, v50
  s_nop 1
  v_max_f32_dpp v76, v76, v76 row_ror:8 row_mask:0xf bank_mask:0xf
  s_nop 1
  v_max_f32_dpp v76, v76, v76 row_ror:4 row_mask:0xf bank_mask:0xf
  s_nop 1
  v_max_f32_dpp v76, v76, v76 row_ror:2 row_mask:0xf bank_mask:0xf
  s_nop 1
  v_max_f32_dpp v76, v76, v76 row_ror:1 row_mask:0xf bank_mask:0xf
  s_nop 1
  v_max_f32_dpp v76, v76, v76 row_bcast:15 row_mask:0xa bank_mask:0xf
  s_nop 1
  v_max_f32_dpp v76, v76, v76 row_bcast:31 row_mask:0xc bank_mask:0xf
  s_nop 0
  v_readlane_b32 s68, v76, 63
  s_nop 1
  v_subrev_f32 v48, s68, v48
  v_subrev_f32 v49, s68, v49
  v_subrev_f32 v50, s68, v50
  v_exp_f32 v48, v48
  v_exp_f32 v49, v49
  v_exp_f32 v50, v50
  s_nop 0
  v_cvt_pk_bf16_f32 v53, v48, v48
  v_cvt_pk_bf16_f32 v54, v49, v49
  v_cvt_pk_bf16_f32 v55, v50, v50
  v_mov_b32 v76, v48
  v_add_f32 v76, v76, v49
  v_add_f32 v76, v76, v50
  s_nop 1
  v_add_f32_dpp v76, v76, v76 row_ror:8 row_mask:0xf bank_mask:0xf
  s_nop 1
  v_add_f32_dpp v76, v76, v76 row_ror:4 row_mask:0xf bank_mask:0xf
  s_nop 1
  v_add_f32_dpp v76, v76, v76 row_ror:2 row_mask:0xf bank_mask:0xf
  s_nop 1
  v_add_f32_dpp v76, v76, v76 row_ror:1 row_mask:0xf bank_mask:0xf
  s_nop 1
  v_add_f32_dpp v76, v76, v76 row_bcast:15 row_mask:0xa bank_mask:0xf
  s_nop 1
  v_add_f32_dpp v76, v76, v76 row_bcast:31 row_mask:0xc bank_mask:0xf
  s_nop 0
  v_readlane_b32 s69, v76, 63
  s_nop 1
  s_nop 1
  v_and_b32_dpp v60, v53, v6 row_newbcast:0 row_mask:0xf bank_mask:0xf
  v_and_b32_dpp v61, v53, v7 row_newbcast:0 row_mask:0xf bank_mask:0xf
  v_and_b32_dpp v62, v53, v8 row_newbcast:0 row_mask:0xf bank_mask:0xf
  v_and_b32_dpp v63, v53, v9 row_newbcast:0 row_mask:0xf bank_mask:0xf
  v_and_b32_dpp v64, v53, v6 row_newbcast:4 row_mask:0xf bank_mask:0xf
  v_and_b32_dpp v65, v53, v7 row_newbcast:4 row_mask:0xf bank_mask:0xf
  v_and_b32_dpp v66, v53, v8 row_newbcast:4 row_mask:0xf bank_mask:0xf
  v_and_b32_dpp v67, v53, v9 row_newbcast:4 row_mask:0xf bank_mask:0xf
  s_waitcnt vmcnt(31)
  v_mfma_f32_16x16x32_bf16 v[68:71], v[60:63], v[188:191], 0
  global_load_dwordx4 v[188:191], v3, s[34:35] offset:-4096 nt
  s_cmp_lg_u32 s3, 0
  s_cbranch_scc1 L_vi11
  v_and_b32 v108, 31, v1
  v_lshlrev_b32 v109, 8, v108
  v_lshlrev_b32 v108, 2, v108
  v_lshrrev_b32 v110, 5, v1
  v_lshl_add_u32 v109, v110, 5, v109
  s_lshl_b32 s65, s61, 3
  s_add_u32 s65, s65, 1310720
  v_add_u32 v109, s65, v109
  global_load_dword v110, v108, s[28:29] sc1
  global_load_dwordx2 v[112:113], v109, s[30:31] sc1
L_vi11:
  v_and_b32_dpp v60, v53, v6 row_newbcast:8 row_mask:0xf bank_mask:0xf
  v_and_b32_dpp v61, v53, v7 row_newbcast:8 row_mask:0xf bank_mask:0xf
  v_and_b32_dpp v62, v53, v8 row_newbcast:8 row_mask:0xf bank_mask:0xf
  v_and_b32_dpp v63, v53, v9 row_newbcast:8 row_mask:0xf bank_mask:0xf
  s_waitcnt vmcnt(31)
  v_mfma_f32_16x16x32_bf16 v[68:71], v[64:67], v[192:195], v[68:71]
  global_load_dwordx4 v[192:195], v3, s[34:35] offset:-3072 nt
  v_and_b32_dpp v64, v53, v6 row_newbcast:12 row_mask:0xf bank_mask:0xf
  v_and_b32_dpp v65, v53, v7 row_newbcast:12 row_mask:0xf bank_mask:0xf
  v_and_b32_dpp v66, v53, v8 row_newbcast:12 row_mask:0xf bank_mask:0xf
  v_and_b32_dpp v67, v53, v9 row_newbcast:12 row_mask:0xf bank_mask:0xf
  s_waitcnt vmcnt(31)
  v_mfma_f32_16x16x32_bf16 v[68:71], v[60:63], v[196:199], v[68:71]
  global_load_dwordx4 v[196:199], v3, s[34:35] offset:-2048 nt
  v_and_b32_dpp v60, v53, v6 row_newbcast:1 row_mask:0xf bank_mask:0xf
  v_and_b32_dpp v61, v53, v7 row_newbcast:1 row_mask:0xf bank_mask:0xf
  v_and_b32_dpp v62, v53, v8 row_newbcast:1 row_mask:0xf bank_mask:0xf
  v_and_b32_dpp v63, v53, v9 row_newbcast:1 row_mask:0xf bank_mask:0xf
  s_waitcnt vmcnt(31)
  v_mfma_f32_16x16x32_bf16 v[68:71], v[64:67], v[200:203], v[68:71]
  global_load_dwordx4 v[200:203], v3, s[34:35] offset:-1024 nt
  v_and_b32_dpp v64, v53, v6 row_newbcast:5 row_mask:0xf bank_mask:0xf
  v_and_b32_dpp v65, v53, v7 row_newbcast:5 row_mask:0xf bank_mask:0xf
  v_and_b32_dpp v66, v53, v8 row_newbcast:5 row_mask:0xf bank_mask:0xf
  v_and_b32_dpp v67, v53, v9 row_newbcast:5 row_mask:0xf bank_mask:0xf
  s_waitcnt vmcnt(31)
  v_mfma_f32_16x16x32_bf16 v[68:71], v[60:63], v[204:207], v[68:71]
  global_load_dwordx4 v[204:207], v3, s[34:35] offset:0 nt
  v_and_b32_dpp v60, v53, v6 row_newbcast:9 row_mask:0xf bank_mask:0xf
  v_and_b32_dpp v61, v53, v7 row_newbcast:9 row_mask:0xf bank_mask:0xf
  v_and_b32_dpp v62, v53, v8 row_newbcast:9 row_mask:0xf bank_mask:0xf
  v_and_b32_dpp v63, v53, v9 row_newbcast:9 row_mask:0xf bank_mask:0xf
  s_waitcnt vmcnt(31)
  v_mfma_f32_16x16x32_bf16 v[68:71], v[64:67], v[208:211], v[68:71]
  global_load_dwordx4 v[208:211], v3, s[34:35] offset:1024 nt
  v_and_b32_dpp v64, v53, v6 row_newbcast:13 row_mask:0xf bank_mask:0xf
  v_and_b32_dpp v65, v53, v7 row_newbcast:13 row_mask:0xf bank_mask:0xf
  v_and_b32_dpp v66, v53, v8 row_newbcast:13 row_mask:0xf bank_mask:0xf
  v_and_b32_dpp v67, v53, v9 row_newbcast:13 row_mask:0xf bank_mask:0xf
  s_waitcnt vmcnt(31)
  v_mfma_f32_16x16x32_bf16 v[68:71], v[60:63], v[212:215], v[68:71]
  global_load_dwordx4 v[212:215], v3, s[34:35] offset:2048 nt
  v_and_b32_dpp v60, v53, v6 row_newbcast:2 row_mask:0xf bank_mask:0xf
  v_and_b32_dpp v61, v53, v7 row_newbcast:2 row_mask:0xf bank_mask:0xf
  v_and_b32_dpp v62, v53, v8 row_newbcast:2 row_mask:0xf bank_mask:0xf
  v_and_b32_dpp v63, v53, v9 row_newbcast:2 row_mask:0xf bank_mask:0xf
  s_waitcnt vmcnt(31)
  v_mfma_f32_16x16x32_bf16 v[68:71], v[64:67], v[216:219], v[68:71]
  global_load_dwordx4 v[216:219], v3, s[34:35] offset:3072 nt
  s_add_u32 s34, s34, 0x10000
  s_addc_u32 s35, s35, 0
  v_and_b32_dpp v64, v53, v6 row_newbcast:6 row_mask:0xf bank_mask:0xf
  v_and_b32_dpp v65, v53, v7 row_newbcast:6 row_mask:0xf bank_mask:0xf
  v_and_b32_dpp v66, v53, v8 row_newbcast:6 row_mask:0xf bank_mask:0xf
  v_and_b32_dpp v67, v53, v9 row_newbcast:6 row_mask:0xf bank_mask:0xf
  s_waitcnt vmcnt(31)
  v_mfma_f32_16x16x32_bf16 v[68:71], v[60:63], v[220:223], v[68:71]
  global_load_dwordx4 v[220:223], v3, s[34:35] offset:-4096 nt
  v_and_b32_dpp v60, v53, v6 row_newbcast:10 row_mask:0xf bank_mask:0xf
  v_and_b32_dpp v61, v53, v7 row_newbcast:10 row_mask:0xf bank_mask:0xf
  v_and_b32_dpp v62, v53, v8 row_newbcast:10 row_mask:0xf bank_mask:0xf
  v_and_b32_dpp v63, v53, v9 row_newbcast:10 row_mask:0xf bank_mask:0xf
  s_waitcnt vmcnt(31)
  v_mfma_f32_16x16x32_bf16 v[68:71], v[64:67], v[224:227], v[68:71]
  global_load_dwordx4 v[224:227], v3, s[34:35] offset:-3072 nt
  v_and_b32_dpp v64, v53, v6 row_newbcast:14 row_mask:0xf bank_mask:0xf
  v_and_b32_dpp v65, v53, v7 row_newbcast:14 row_mask:0xf bank_mask:0xf
  v_and_b32_dpp v66, v53, v8 row_newbcast:14 row_mask:0xf bank_mask:0xf
  v_and_b32_dpp v67, v53, v9 row_newbcast:14 row_mask:0xf bank_mask:0xf
  s_waitcnt vmcnt(31)
  v_mfma_f32_16x16x32_bf16 v[68:71], v[60:63], v[228:231], v[68:71]
  global_load_dwordx4 v[228:231], v3, s[34:35] offset:-2048 nt
  v_and_b32_dpp v60, v53, v6 row_newbcast:3 row_mask:0xf bank_mask:0xf
  v_and_b32_dpp v61, v53, v7 row_newbcast:3 row_mask:0xf bank_mask:0xf
  v_and_b32_dpp v62, v53, v8 row_newbcast:3 row_mask:0xf bank_mask:0xf
  v_and_b32_dpp v63, v53, v9 row_newbcast:3 row_mask:0xf bank_mask:0xf
  s_waitcnt vmcnt(31)
  v_mfma_f32_16x16x32_bf16 v[68:71], v[64:67], v[232:235], v[68:71]
  global_load_dwordx4 v[232:235], v3, s[34:35] offset:-1024 nt
  v_and_b32_dpp v64, v53, v6 row_newbcast:7 row_mask:0xf bank_mask:0xf
  v_and_b32_dpp v65, v53, v7 row_newbcast:7 row_mask:0xf bank_mask:0xf
  v_and_b32_dpp v66, v53, v8 row_newbcast:7 row_mask:0xf bank_mask:0xf
  v_and_b32_dpp v67, v53, v9 row_newbcast:7 row_mask:0xf bank_mask:0xf
  s_waitcnt vmcnt(31)
  v_mfma_f32_16x16x32_bf16 v[68:71], v[60:63], v[236:239], v[68:71]
  global_load_dwordx4 v[236:239], v3, s[34:35] offset:0 nt
  v_and_b32_dpp v60, v53, v6 row_newbcast:11 row_mask:0xf bank_mask:0xf
  v_and_b32_dpp v61, v53, v7 row_newbcast:11 row_mask:0xf bank_mask:0xf
  v_and_b32_dpp v62, v53, v8 row_newbcast:11 row_mask:0xf bank_mask:0xf
  v_and_b32_dpp v63, v53, v9 row_newbcast:11 row_mask:0xf bank_mask:0xf
  s_waitcnt vmcnt(31)
  v_mfma_f32_16x16x32_bf16 v[68:71], v[64:67], v[240:243], v[68:71]
  global_load_dwordx4 v[240:243], v3, s[34:35] offset:1024 nt
  v_and_b32_dpp v64, v53, v6 row_newbcast:15 row_mask:0xf bank_mask:0xf
  v_and_b32_dpp v65, v53, v7 row_newbcast:15 row_mask:0xf bank_mask:0xf
  v_and_b32_dpp v66, v53, v8 row_newbcast:15 row_mask:0xf bank_mask:0xf
  v_and_b32_dpp v67, v53, v9 row_newbcast:15 row_mask:0xf bank_mask:0xf
  s_waitcnt vmcnt(31)
  v_mfma_f32_16x16x32_bf16 v[68:71], v[60:63], v[244:247], v[68:71]
  global_load_dwordx4 v[244:247], v3, s[34:35] offset:2048 nt
  s_nop 0
  s_waitcnt vmcnt(31)
  v_mfma_f32_16x16x32_bf16 v[68:71], v[64:67], v[248:251], v[68:71]
  global_load_dwordx4 v[248:251], v3, s[34:35] offset:3072 nt
  s_add_u32 s34, s34, 0x10000
  s_addc_u32 s35, s35, 0
  s_nop 1
  v_and_b32_dpp v60, v54, v6 row_newbcast:0 row_mask:0xf bank_mask:0xf
  v_and_b32_dpp v61, v54, v7 row_newbcast:0 row_mask:0xf bank_mask:0xf
  v_and_b32_dpp v62, v54, v8 row_newbcast:0 row_mask:0xf bank_mask:0xf
  v_and_b32_dpp v63, v54, v9 row_newbcast:0 row_mask:0xf bank_mask:0xf
  v_and_b32_dpp v64, v54, v6 row_newbcast:4 row_mask:0xf bank_mask:0xf
  v_and_b32_dpp v65, v54, v7 row_newbcast:4 row_mask:0xf bank_mask:0xf
  v_and_b32_dpp v66, v54, v8 row_newbcast:4 row_mask:0xf bank_mask:0xf
  v_and_b32_dpp v67, v54, v9 row_newbcast:4 row_mask:0xf bank_mask:0xf
  s_waitcnt vmcnt(31)
  v_mfma_f32_16x16x32_bf16 v[68:71], v[60:63], v[124:127], v[68:71]
  global_load_dwordx4 v[124:127], v2, s[36:37] offset:-4096 nt
  v_and_b32_dpp v60, v54, v6 row_newbcast:8 row_mask:0xf bank_mask:0xf
  v_and_b32_dpp v61, v54, v7 row_newbcast:8 row_mask:0xf bank_mask:0xf
  v_and_b32_dpp v62, v54, v8 row_newbcast:8 row_mask:0xf bank_mask:0xf
  v_and_b32_dpp v63, v54, v9 row_newbcast:8 row_mask:0xf bank_mask:0xf
  s_waitcnt vmcnt(31)
  v_mfma_f32_16x16x32_bf16 v[68:71], v[64:67], v[128:131], v[68:71]
  global_load_dwordx4 v[128:131], v2, s[36:37] offset:-3072 nt
  v_and_b32_dpp v64, v54, v6 row_newbcast:12 row_mask:0xf bank_mask:0xf
  v_and_b32_dpp v65, v54, v7 row_newbcast:12 row_mask:0xf bank_mask:0xf
  v_and_b32_dpp v66, v54, v8 row_newbcast:12 row_mask:0xf bank_mask:0xf
  v_and_b32_dpp v67, v54, v9 row_newbcast:12 row_mask:0xf bank_mask:0xf
  s_waitcnt vmcnt(31)
  v_mfma_f32_16x16x32_bf16 v[68:71], v[60:63], v[132:135], v[68:71]
  global_load_dwordx4 v[132:135], v2, s[36:37] offset:-2048 nt
  v_and_b32_dpp v60, v54, v6 row_newbcast:1 row_mask:0xf bank_mask:0xf
  v_and_b32_dpp v61, v54, v7 row_newbcast:1 row_mask:0xf bank_mask:0xf
  v_and_b32_dpp v62, v54, v8 row_newbcast:1 row_mask:0xf bank_mask:0xf
  v_and_b32_dpp v63, v54, v9 row_newbcast:1 row_mask:0xf bank_mask:0xf
  s_waitcnt vmcnt(31)
  v_mfma_f32_16x16x32_bf16 v[68:71], v[64:67], v[136:139], v[68:71]
  global_load_dwordx4 v[136:139], v2, s[36:37] offset:-1024 nt
  v_and_b32_dpp v64, v54, v6 row_newbcast:5 row_mask:0xf bank_mask:0xf
  v_and_b32_dpp v65, v54, v7 row_newbcast:5 row_mask:0xf bank_mask:0xf
  v_and_b32_dpp v66, v54, v8 row_newbcast:5 row_mask:0xf bank_mask:0xf
  v_and_b32_dpp v67, v54, v9 row_newbcast:5 row_mask:0xf bank_mask:0xf
  s_waitcnt vmcnt(31)
  v_mfma_f32_16x16x32_bf16 v[68:71], v[60:63], v[140:143], v[68:71]
  global_load_dwordx4 v[140:143], v2, s[36:37] offset:0 nt
  v_and_b32_dpp v60, v54, v6 row_newbcast:9 row_mask:0xf bank_mask:0xf
  v_and_b32_dpp v61, v54, v7 row_newbcast:9 row_mask:0xf bank_mask:0xf
  v_and_b32_dpp v62, v54, v8 row_newbcast:9 row_mask:0xf bank_mask:0xf
  v_and_b32_dpp v63, v54, v9 row_newbcast:9 row_mask:0xf bank_mask:0xf
  s_waitcnt vmcnt(31)
  v_mfma_f32_16x16x32_bf16 v[68:71], v[64:67], v[144:147], v[68:71]
  global_load_dwordx4 v[144:147], v2, s[36:37] offset:1024 nt
  v_and_b32_dpp v64, v54, v6 row_newbcast:13 row_mask:0xf bank_mask:0xf
  v_and_b32_dpp v65, v54, v7 row_newbcast:13 row_mask:0xf bank_mask:0xf
  v_and_b32_dpp v66, v54, v8 row_newbcast:13 row_mask:0xf bank_mask:0xf
  v_and_b32_dpp v67, v54, v9 row_newbcast:13 row_mask:0xf bank_mask:0xf
  s_waitcnt vmcnt(31)
  v_mfma_f32_16x16x32_bf16 v[68:71], v[60:63], v[148:151], v[68:71]
  global_load_dwordx4 v[148:151], v2, s[36:37] offset:2048 nt
  v_and_b32_dpp v60, v54, v6 row_newbcast:2 row_mask:0xf bank_mask:0xf
  v_and_b32_dpp v61, v54, v7 row_newbcast:2 row_mask:0xf bank_mask:0xf
  v_and_b32_dpp v62, v54, v8 row_newbcast:2 row_mask:0xf bank_mask:0xf
  v_and_b32_dpp v63, v54, v9 row_newbcast:2 row_mask:0xf bank_mask:0xf
  s_waitcnt vmcnt(31)
  v_mfma_f32_16x16x32_bf16 v[68:71], v[64:67], v[152:155], v[68:71]
  global_load_dwordx4 v[152:155], v2, s[36:37] offset:3072 nt
  s_add_u32 s36, s36, 0x10000
  s_addc_u32 s37, s37, 0
  v_and_b32_dpp v64, v54, v6 row_newbcast:6 row_mask:0xf bank_mask:0xf
  v_and_b32_dpp v65, v54, v7 row_newbcast:6 row_mask:0xf bank_mask:0xf
  v_and_b32_dpp v66, v54, v8 row_newbcast:6 row_mask:0xf bank_mask:0xf
  v_and_b32_dpp v67, v54, v9 row_newbcast:6 row_mask:0xf bank_mask:0xf
  s_waitcnt vmcnt(31)
  v_mfma_f32_16x16x32_bf16 v[68:71], v[60:63], v[156:159], v[68:71]
  global_load_dwordx4 v[156:159], v2, s[36:37] offset:-4096 nt
  v_and_b32_dpp v60, v54, v6 row_newbcast:10 row_mask:0xf bank_mask:0xf
  v_and_b32_dpp v61, v54, v7 row_newbcast:10 row_mask:0xf bank_mask:0xf
  v_and_b32_dpp v62, v54, v8 row_newbcast:10 row_mask:0xf bank_mask:0xf
  v_and_b32_dpp v63, v54, v9 row_newbcast:10 row_mask:0xf bank_mask:0xf
  s_waitcnt vmcnt(31)
  v_mfma_f32_16x16x32_bf16 v[68:71], v[64:67], v[160:163], v[68:71]
  global_load_dwordx4 v[160:163], v2, s[36:37] offset:-3072 nt
  v_and_b32_dpp v64, v54, v6 row_newbcast:14 row_mask:0xf bank_mask:0xf
  v_and_b32_dpp v65, v54, v7 row_newbcast:14 row_mask:0xf bank_mask:0xf
  v_and_b32_dpp v66, v54, v8 row_newbcast:14 row_mask:0xf bank_mask:0xf
  v_and_b32_dpp v67, v54, v9 row_newbcast:14 row_mask:0xf bank_mask:0xf
  s_waitcnt vmcnt(31)
  v_mfma_f32_16x16x32_bf16 v[68:71], v[60:63], v[164:167], v[68:71]
  global_load_dwordx4 v[164:167], v2, s[36:37] offset:-2048 nt
  v_and_b32_dpp v60, v54, v6 row_newbcast:3 row_mask:0xf bank_mask:0xf
  v_and_b32_dpp v61, v54, v7 row_newbcast:3 row_mask:0xf bank_mask:0xf
  v_and_b32_dpp v62, v54, v8 row_newbcast:3 row_mask:0xf bank_mask:0xf
  v_and_b32_dpp v63, v54, v9 row_newbcast:3 row_mask:0xf bank_mask:0xf
  s_waitcnt vmcnt(31)
  v_mfma_f32_16x16x32_bf16 v[68:71], v[64:67], v[168:171], v[68:71]
  global_load_dwordx4 v[168:171], v2, s[36:37] offset:-1024 nt
  v_and_b32_dpp v64, v54, v6 row_newbcast:7 row_mask:0xf bank_mask:0xf
  v_and_b32_dpp v65, v54, v7 row_newbcast:7 row_mask:0xf bank_mask:0xf
  v_and_b32_dpp v66, v54, v8 row_newbcast:7 row_mask:0xf bank_mask:0xf
  v_and_b32_dpp v67, v54, v9 row_newbcast:7 row_mask:0xf bank_mask:0xf
  s_waitcnt vmcnt(31)
  v_mfma_f32_16x16x32_bf16 v[68:71], v[60:63], v[172:175], v[68:71]
  global_load_dwordx4 v[172:175], v2, s[36:37] offset:0 nt
  v_and_b32_dpp v60, v54, v6 row_newbcast:11 row_mask:0xf bank_mask:0xf
  v_and_b32_dpp v61, v54, v7 row_newbcast:11 row_mask:0xf bank_mask:0xf
  v_and_b32_dpp v62, v54, v8 row_newbcast:11 row_mask:0xf bank_mask:0xf
  v_and_b32_dpp v63, v54, v9 row_newbcast:11 row_mask:0xf bank_mask:0xf
  s_waitcnt vmcnt(31)
  v_mfma_f32_16x16x32_bf16 v[68:71], v[64:67], v[176:179], v[68:71]
  global_load_dwordx4 v[176:179], v2, s[36:37] offset:1024 nt
  v_and_b32_dpp v64, v54, v6 row_newbcast:15 row_mask:0xf bank_mask:0xf
  v_and_b32_dpp v65, v54, v7 row_newbcast:15 row_mask:0xf bank_mask:0xf
  v_and_b32_dpp v66, v54, v8 row_newbcast:15 row_mask:0xf bank_mask:0xf
  v_and_b32_dpp v67, v54, v9 row_newbcast:15 row_mask:0xf bank_mask:0xf
  s_waitcnt vmcnt(31)
  v_mfma_f32_16x16x32_bf16 v[68:71], v[60:63], v[180:183], v[68:71]
  global_load_dwordx4 v[180:183], v2, s[36:37] offset:2048 nt
  s_nop 0
  s_waitcnt vmcnt(31)
  v_mfma_f32_16x16x32_bf16 v[68:71], v[64:67], v[184:187], v[68:71]
  global_load_dwordx4 v[184:187], v2, s[36:37] offset:3072 nt
  s_add_u32 s36, s36, 0x10000
  s_addc_u32 s37, s37, 0
  s_nop 1
  v_and_b32_dpp v60, v55, v6 row_newbcast:0 row_mask:0xf bank_mask:0xf
  v_and_b32_dpp v61, v55, v7 row_newbcast:0 row_mask:0xf bank_mask:0xf
  v_and_b32_dpp v62, v55, v8 row_newbcast:0 row_mask:0xf bank_mask:0xf
  v_and_b32_dpp v63, v55, v9 row_newbcast:0 row_mask:0xf bank_mask:0xf
  v_and_b32_dpp v64, v55, v6 row_newbcast:4 row_mask:0xf bank_mask:0xf
  v_and_b32_dpp v65, v55, v7 row_newbcast:4 row_mask:0xf bank_mask:0xf
  v_and_b32_dpp v66, v55, v8 row_newbcast:4 row_mask:0xf bank_mask:0xf
  v_and_b32_dpp v67, v55, v9 row_newbcast:4 row_mask:0xf bank_mask:0xf
  s_waitcnt vmcnt(31)
  v_mfma_f32_16x16x32_bf16 v[68:71], v[60:63], v[188:191], v[68:71]
  global_load_dwordx4 v[188:191], v2, s[36:37] offset:-4096 nt
  s_cmp_lg_u32 s3, 0
  s_cbranch_scc1 L_vc12
  s_mov_b32 s78, 0
L_vc12a:
  v_not_b32 v111, v110
  v_cmp_eq_u64 vcc, v[112:113], v[110:111]
  v_cmp_ne_u32 s[70:71], 0, v110
  s_and_b64 vcc, vcc, s[70:71]
  s_cmp_eq_u64 vcc, -1
  s_cbranch_scc1 L_vc12
  s_add_u32 s78, s78, 1
  s_cmp_gt_u32 s78, 0x200000
  s_cbranch_scc1 L_vc12
  v_and_b32 v108, 31, v1
  v_lshlrev_b32 v109, 8, v108
  v_lshlrev_b32 v108, 2, v108
  v_lshrrev_b32 v110, 5, v1
  v_lshl_add_u32 v109, v110, 5, v109
  s_lshl_b32 s65, s61, 3
  s_add_u32 s65, s65, 1310720
  v_add_u32 v109, s65, v109
  global_load_dword v110, v108, s[28:29] sc1
  global_load_dwordx2 v[112:113], v109, s[30:31] sc1
  s_waitcnt vmcnt(0)
  s_branch L_vc12a
L_vc12:
  v_and_b32_dpp v60, v55, v6 row_newbcast:8 row_mask:0xf bank_mask:0xf
  v_and_b32_dpp v61, v55, v7 row_newbcast:8 row_mask:0xf bank_mask:0xf
  v_and_b32_dpp v62, v55, v8 row_newbcast:8 row_mask:0xf bank_mask:0xf
  v_and_b32_dpp v63, v55, v9 row_newbcast:8 row_mask:0xf bank_mask:0xf
  s_waitcnt vmcnt(31)
  v_mfma_f32_16x16x32_bf16 v[68:71], v[64:67], v[192:195], v[68:71]
  global_load_dwordx4 v[192:195], v2, s[36:37] offset:-3072 nt
  v_and_b32_dpp v64, v55, v6 row_newbcast:12 row_mask:0xf bank_mask:0xf
  v_and_b32_dpp v65, v55, v7 row_newbcast:12 row_mask:0xf bank_mask:0xf
  v_and_b32_dpp v66, v55, v8 row_newbcast:12 row_mask:0xf bank_mask:0xf
  v_and_b32_dpp v67, v55, v9 row_newbcast:12 row_mask:0xf bank_mask:0xf
  s_waitcnt vmcnt(31)
  v_mfma_f32_16x16x32_bf16 v[68:71], v[60:63], v[196:199], v[68:71]
  global_load_dwordx4 v[196:199], v2, s[36:37] offset:-2048 nt
  v_and_b32_dpp v60, v55, v6 row_newbcast:1 row_mask:0xf bank_mask:0xf
  v_and_b32_dpp v61, v55, v7 row_newbcast:1 row_mask:0xf bank_mask:0xf
  v_and_b32_dpp v62, v55, v8 row_newbcast:1 row_mask:0xf bank_mask:0xf
  v_and_b32_dpp v63, v55, v9 row_newbcast:1 row_mask:0xf bank_mask:0xf
  s_waitcnt vmcnt(31)
  v_mfma_f32_16x16x32_bf16 v[68:71], v[64:67], v[200:203], v[68:71]
  global_load_dwordx4 v[200:203], v2, s[36:37] offset:-1024 nt
  v_and_b32_dpp v64, v55, v6 row_newbcast:5 row_mask:0xf bank_mask:0xf
  v_and_b32_dpp v65, v55, v7 row_newbcast:5 row_mask:0xf bank_mask:0xf
  v_and_b32_dpp v66, v55, v8 row_newbcast:5 row_mask:0xf bank_mask:0xf
  v_and_b32_dpp v67, v55, v9 row_newbcast:5 row_mask:0xf bank_mask:0xf
  s_waitcnt vmcnt(31)
  v_mfma_f32_16x16x32_bf16 v[68:71], v[60:63], v[204:207], v[68:71]
  global_load_dwordx4 v[204:207], v2, s[36:37] offset:0 nt
  v_and_b32_dpp v60, v55, v6 row_newbcast:9 row_mask:0xf bank_mask:0xf
  v_and_b32_dpp v61, v55, v7 row_newbcast:9 row_mask:0xf bank_mask:0xf
  v_and_b32_dpp v62, v55, v8 row_newbcast:9 row_mask:0xf bank_mask:0xf
  v_and_b32_dpp v63, v55, v9 row_newbcast:9 row_mask:0xf bank_mask:0xf
  s_waitcnt vmcnt(31)
  v_mfma_f32_16x16x32_bf16 v[68:71], v[64:67], v[208:211], v[68:71]
  global_load_dwordx4 v[208:211], v2, s[36:37] offset:1024 nt
  v_and_b32_dpp v64, v55, v6 row_newbcast:13 row_mask:0xf bank_mask:0xf
  v_and_b32_dpp v65, v55, v7 row_newbcast:13 row_mask:0xf bank_mask:0xf
  v_and_b32_dpp v66, v55, v8 row_newbcast:13 row_mask:0xf bank_mask:0xf
  v_and_b32_dpp v67, v55, v9 row_newbcast:13 row_mask:0xf bank_mask:0xf
  s_waitcnt vmcnt(31)
  v_mfma_f32_16x16x32_bf16 v[68:71], v[60:63], v[212:215], v[68:71]
  global_load_dwordx4 v[212:215], v2, s[36:37] offset:2048 nt
  v_and_b32_dpp v60, v55, v6 row_newbcast:2 row_mask:0xf bank_mask:0xf
  v_and_b32_dpp v61, v55, v7 row_newbcast:2 row_mask:0xf bank_mask:0xf
  v_and_b32_dpp v62, v55, v8 row_newbcast:2 row_mask:0xf bank_mask:0xf
  v_and_b32_dpp v63, v55, v9 row_newbcast:2 row_mask:0xf bank_mask:0xf
  s_waitcnt vmcnt(31)
  v_mfma_f32_16x16x32_bf16 v[68:71], v[64:67], v[216:219], v[68:71]
  global_load_dwordx4 v[216:219], v2, s[36:37] offset:3072 nt
  s_add_u32 s36, s36, 0x10000
  s_addc_u32 s37, s37, 0
  v_and_b32_dpp v64, v55, v6 row_newbcast:6 row_mask:0xf bank_mask:0xf
  v_and_b32_dpp v65, v55, v7 row_newbcast:6 row_mask:0xf bank_mask:0xf
  v_and_b32_dpp v66, v55, v8 row_newbcast:6 row_mask:0xf bank_mask:0xf
  v_and_b32_dpp v67, v55, v9 row_newbcast:6 row_mask:0xf bank_mask:0xf
  s_waitcnt vmcnt(31)
  v_mfma_f32_16x16x32_bf16 v[68:71], v[60:63], v[220:223], v[68:71]
  global_load_dwordx4 v[220:223], v2, s[36:37] offset:-4096 nt
  v_and_b32_dpp v60, v55, v6 row_newbcast:10 row_mask:0xf bank_mask:0xf
  v_and_b32_dpp v61, v55, v7 row_newbcast:10 row_mask:0xf bank_mask:0xf
  v_and_b32_dpp v62, v55, v8 row_newbcast:10 row_mask:0xf bank_mask:0xf
  v_and_b32_dpp v63, v55, v9 row_newbcast:10 row_mask:0xf bank_mask:0xf
  s_waitcnt vmcnt(31)
  v_mfma_f32_16x16x32_bf16 v[68:71], v[64:67], v[224:227], v[68:71]
  global_load_dwordx4 v[224:227], v2, s[36:37] offset:-3072 nt
  v_and_b32_dpp v64, v55, v6 row_newbcast:14 row_mask:0xf bank_mask:0xf
  v_and_b32_dpp v65, v55, v7 row_newbcast:14 row_mask:0xf bank_mask:0xf
  v_and_b32_dpp v66, v55, v8 row_newbcast:14 row_mask:0xf bank_mask:0xf
  v_and_b32_dpp v67, v55, v9 row_newbcast:14 row_mask:0xf bank_mask:0xf
  s_waitcnt vmcnt(31)
  v_mfma_f32_16x16x32_bf16 v[68:71], v[60:63], v[228:231], v[68:71]
  global_load_dwordx4 v[228:231], v2, s[36:37] offset:-2048 nt
  v_and_b32_dpp v60, v55, v6 row_newbcast:3 row_mask:0xf bank_mask:0xf
  v_and_b32_dpp v61, v55, v7 row_newbcast:3 row_mask:0xf bank_mask:0xf
  v_and_b32_dpp v62, v55, v8 row_newbcast:3 row_mask:0xf bank_mask:0xf
  v_and_b32_dpp v63, v55, v9 row_newbcast:3 row_mask:0xf bank_mask:0xf
  s_waitcnt vmcnt(31)
  v_mfma_f32_16x16x32_bf16 v[68:71], v[64:67], v[232:235], v[68:71]
  global_load_dwordx4 v[232:235], v2, s[36:37] offset:-1024 nt
  v_and_b32_dpp v64, v55, v6 row_newbcast:7 row_mask:0xf bank_mask:0xf
  v_and_b32_dpp v65, v55, v7 row_newbcast:7 row_mask:0xf bank_mask:0xf
  v_and_b32_dpp v66, v55, v8 row_newbcast:7 row_mask:0xf bank_mask:0xf
  v_and_b32_dpp v67, v55, v9 row_newbcast:7 row_mask:0xf bank_mask:0xf
  s_waitcnt vmcnt(31)
  v_mfma_f32_16x16x32_bf16 v[68:71], v[60:63], v[236:239], v[68:71]
  global_load_dwordx4 v[236:239], v2, s[36:37] offset:0 nt
  v_and_b32_dpp v60, v55, v6 row_newbcast:11 row_mask:0xf bank_mask:0xf
  v_and_b32_dpp v61, v55, v7 row_newbcast:11 row_mask:0xf bank_mask:0xf
  v_and_b32_dpp v62, v55, v8 row_newbcast:11 row_mask:0xf bank_mask:0xf
  v_and_b32_dpp v63, v55, v9 row_newbcast:11 row_mask:0xf bank_mask:0xf
  s_waitcnt vmcnt(31)
  v_mfma_f32_16x16x32_bf16 v[68:71], v[64:67], v[240:243], v[68:71]
  global_load_dwordx4 v[240:243], v2, s[36:37] offset:1024 nt
  v_and_b32_dpp v64, v55, v6 row_newbcast:15 row_mask:0xf bank_mask:0xf
  v_and_b32_dpp v65, v55, v7 row_newbcast:15 row_mask:0xf bank_mask:0xf
  v_and_b32_dpp v66, v55, v8 row_newbcast:15 row_mask:0xf bank_mask:0xf
  v_and_b32_dpp v67, v55, v9 row_newbcast:15 row_mask:0xf bank_mask:0xf
  s_waitcnt vmcnt(31)
  v_mfma_f32_16x16x32_bf16 v[68:71], v[60:63], v[244:247], v[68:71]
  global_load_dwordx4 v[244:247], v2, s[36:37] offset:2048 nt
  s_nop 0
  s_waitcnt vmcnt(31)
  v_mfma_f32_16x16x32_bf16 v[68:71], v[64:67], v[248:251], v[68:71]
  global_load_dwordx4 v[248:251], v2, s[36:37] offset:3072 nt
  s_add_u32 s36, s36, 0x10000
  s_addc_u32 s37, s37, 0
  v_and_b32 v76, 1, v11
  v_lshlrev_b32 v76, 4, v76
  v_lshl_add_u32 v76, v10, 5, v76
  s_lshl_b32 s64, s3, 9
  s_add_u32 s64, s64, 147968
  v_add_u32 v76, s64, v76
  s_lshl_b32 s64, s3, 3
  s_add_u32 s64, s64, 152576
  v_mov_b32 v77, s64
  v_mov_b32 v78, s68
  v_mov_b32 v79, s69
  ds_write_b64 v77, v[78:79]
  s_nop 3
  ds_write_b128 v76, v[68:71]
  s_waitcnt lgkmcnt(0)
  s_barrier
  s_cmp_lg_u32 s3, 0
  s_cbranch_scc1 L_pub13
  v_mov_b32 v114, 152576
  ds_read_b128 v[76:79], v114 offset:0
  ds_read_b128 v[80:83], v114 offset:16
  ds_read_b128 v[84:87], v114 offset:32
  ds_read_b128 v[88:91], v114 offset:48
  v_lshl_add_u32 v115, v10, 3, v11
  v_lshlrev_b32 v115, 2, v115
  v_add_u32 v115, 147968, v115
  ds_read_b32 v96, v115 offset:0
  ds_read_b32 v97, v115 offset:16
  ds_read_b32 v98, v115 offset:512
  ds_read_b32 v99, v115 offset:528
  ds_read_b32 v100, v115 offset:1024
  ds_read_b32 v101, v115 offset:1040
  ds_read_b32 v102, v115 offset:1536
  ds_read_b32 v103, v115 offset:1552
  ds_read_b32 v104, v115 offset:2048
  ds_read_b32 v105, v115 offset:2064
  ds_read_b32 v106, v115 offset:2560
  ds_read_b32 v107, v115 offset:2576
  ds_read_b32 v108, v115 offset:3072
  ds_read_b32 v109, v115 offset:3088
  ds_read_b32 v110, v115 offset:3584
  ds_read_b32 v111, v115 offset:3600
  s_waitcnt lgkmcnt(0)
  v_max_f32 v117, v76, v78
  v_max_f32 v117, v117, v80
  v_max_f32 v117, v117, v82
  v_max_f32 v117, v117, v84
  v_max_f32 v117, v117, v86
  v_max_f32 v117, v117, v88
  v_max_f32 v117, v117, v90
  v_sub_f32 v76, v76, v117
  v_sub_f32 v78, v78, v117
  v_sub_f32 v80, v80, v117
  v_sub_f32 v82, v82, v117
  v_sub_f32 v84, v84, v117
  v_sub_f32 v86, v86, v117
  v_sub_f32 v88, v88, v117
  v_sub_f32 v90, v90, v117
  v_exp_f32 v76, v76
  v_exp_f32 v78, v78
  v_exp_f32 v80, v80
  v_exp_f32 v82, v82
  v_exp_f32 v84, v84
  v_exp_f32 v86, v86
  v_exp_f32 v88, v88
  v_exp_f32 v90, v90
  s_nop 0
  v_mul_f32 v118, v76, v77
  v_fmac_f32 v118, v78, v79
  v_fmac_f32 v118, v80, v81
  v_fmac_f32 v118, v82, v83
  v_fmac_f32 v118, v84, v85
  v_fmac_f32 v118, v86, v87
  v_fmac_f32 v118, v88, v89
  v_fmac_f32 v118, v90, v91
  v_mul_f32 v115, v76, v96
  v_mul_f32 v116, v76, v97
  v_fmac_f32 v115, v78, v98
  v_fmac_f32 v116, v78, v99
  v_fmac_f32 v115, v80, v100
  v_fmac_f32 v116, v80, v101
  v_fmac_f32 v115, v82, v102
  v_fmac_f32 v116, v82, v103
  v_fmac_f32 v115, v84, v104
  v_fmac_f32 v116, v84, v105
  v_fmac_f32 v115, v86, v106
  v_fmac_f32 v116, v86, v107
  v_fmac_f32 v115, v88, v108
  v_fmac_f32 v116, v88, v109
  v_fmac_f32 v115, v90, v110
  v_fmac_f32 v116, v90, v111
  s_lshl_b32 s64, s63, 10
  s_add_u32 s64, s64, 1048576
  v_lshl_add_u32 v76, v10, 3, v11
  v_lshlrev_b32 v76, 2, v76
  v_add_u32 v76, s64, v76
  global_store_dword v76, v115, s[30:31] sc1
  global_store_dword v76, v116, s[30:31] offset:16 sc1
  v_mov_b32 v78, v117
  v_mov_b32 v79, v118
  s_mov_b64 exec, 1
  global_store_dwordx2 v76, v[78:79], s[30:31] offset:512 sc1
  s_mov_b64 exec, -1
L_pub13:
  v_and_b32 v14, 3, v10
  v_lshl_add_u32 v14, v11, 2, v14
  v_lshlrev_b32 v14, 4, v14
  v_add_u32 v14, 147456, v14
  ds_read_b128 v[76:79], v14 offset:256
  s_waitcnt lgkmcnt(0)
  v_cndmask_b32 v16, 0, v76, s[50:51]
  v_cndmask_b32 v17, 0, v77, s[50:51]
  v_cndmask_b32 v18, 0, v78, s[50:51]
  v_cndmask_b32 v19, 0, v79, s[50:51]
  v_cndmask_b32 v20, 0, v76, s[52:53]
  v_cndmask_b32 v21, 0, v77, s[52:53]
  v_cndmask_b32 v22, 0, v78, s[52:53]
  v_cndmask_b32 v23, 0, v79, s[52:53]
  v_cndmask_b32 v24, 0, v76, s[54:55]
  v_cndmask_b32 v25, 0, v77, s[54:55]
  v_cndmask_b32 v26, 0, v78, s[54:55]
  v_cndmask_b32 v27, 0, v79, s[54:55]
  v_cndmask_b32 v28, 0, v76, s[56:57]
  v_cndmask_b32 v29, 0, v77, s[56:57]
  v_cndmask_b32 v30, 0, v78, s[56:57]
  v_cndmask_b32 v31, 0, v79, s[56:57]
  s_nop 1
  s_waitcnt vmcnt(31)
  v_mfma_f32_16x16x32_bf16 v[32:35], v[124:127], v[16:19], 0
  global_load_dwordx4 v[124:127], v3, s[38:39] offset:-4096 nt
  s_waitcnt vmcnt(31)
  v_mfma_f32_16x16x32_bf16 v[32:35], v[128:131], v[20:23], v[32:35]
  global_load_dwordx4 v[128:131], v3, s[38:39] offset:-3072 nt
  s_waitcnt vmcnt(31)
  v_mfma_f32_16x16x32_bf16 v[32:35], v[132:135], v[24:27], v[32:35]
  global_load_dwordx4 v[132:135], v3, s[38:39] offset:-2048 nt
  s_waitcnt vmcnt(31)
  v_mfma_f32_16x16x32_bf16 v[32:35], v[136:139], v[28:31], v[32:35]
  global_load_dwordx4 v[136:139], v3, s[38:39] offset:-1024 nt
  s_waitcnt vmcnt(31)
  v_mfma_f32_16x16x32_bf16 v[36:39], v[140:143], v[16:19], 0
  global_load_dwordx4 v[140:143], v3, s[38:39] offset:0 nt
  s_waitcnt vmcnt(31)
  v_mfma_f32_16x16x32_bf16 v[36:39], v[144:147], v[20:23], v[36:39]
  global_load_dwordx4 v[144:147], v3, s[38:39] offset:1024 nt
  s_waitcnt vmcnt(31)
  v_mfma_f32_16x16x32_bf16 v[36:39], v[148:151], v[24:27], v[36:39]
  global_load_dwordx4 v[148:151], v3, s[38:39] offset:2048 nt
  s_waitcnt vmcnt(31)
  v_mfma_f32_16x16x32_bf16 v[36:39], v[152:155], v[28:31], v[36:39]
  global_load_dwordx4 v[152:155], v3, s[38:39] offset:3072 nt
  s_add_u32 s38, s38, 0x10000
  s_addc_u32 s39, s39, 0
  s_waitcnt vmcnt(31)
  v_mfma_f32_16x16x32_bf16 v[40:43], v[156:159], v[16:19], 0
  global_load_dwordx4 v[156:159], v3, s[38:39] offset:-4096 nt
  s_waitcnt vmcnt(31)
  v_mfma_f32_16x16x32_bf16 v[40:43], v[160:163], v[20:23], v[40:43]
  global_load_dwordx4 v[160:163], v3, s[38:39] offset:-3072 nt
  s_waitcnt vmcnt(31)
  v_mfma_f32_16x16x32_bf16 v[40:43], v[164:167], v[24:27], v[40:43]
  global_load_dwordx4 v[164:167], v3, s[38:39] offset:-2048 nt
  s_waitcnt vmcnt(31)
  v_mfma_f32_16x16x32_bf16 v[40:43], v[168:171], v[28:31], v[40:43]
  global_load_dwordx4 v[168:171], v3, s[38:39] offset:-1024 nt
  s_waitcnt vmcnt(31)
  v_mfma_f32_16x16x32_bf16 v[44:47], v[172:175], v[16:19], 0
  global_load_dwordx4 v[172:175], v3, s[38:39] offset:0 nt
  s_waitcnt vmcnt(31)
  v_mfma_f32_16x16x32_bf16 v[44:47], v[176:179], v[20:23], v[44:47]
  global_load_dwordx4 v[176:179], v3, s[38:39] offset:1024 nt
  s_waitcnt vmcnt(31)
  v_mfma_f32_16x16x32_bf16 v[44:47], v[180:183], v[24:27], v[44:47]
  global_load_dwordx4 v[180:183], v3, s[38:39] offset:2048 nt
  s_waitcnt vmcnt(31)
  v_mfma_f32_16x16x32_bf16 v[44:47], v[184:187], v[28:31], v[44:47]
  global_load_dwordx4 v[184:187], v3, s[38:39] offset:3072 nt
  s_add_u32 s38, s38, 0x10000
  s_addc_u32 s39, s39, 0
  s_nop 7
  v_mov_b32_dpp v76, v32 quad_perm:[0,0,0,0] row_mask:0xf bank_mask:0xf
  v_add_f32_dpp v76, v33, v76 quad_perm:[1,1,1,1] row_mask:0xf bank_mask:0xf
  v_add_f32_dpp v76, v34, v76 quad_perm:[2,2,2,2] row_mask:0xf bank_mask:0xf
  v_add_f32_dpp v76, v35, v76 quad_perm:[3,3,3,3] row_mask:0xf bank_mask:0xf
  v_mov_b32_dpp v77, v36 quad_perm:[0,0,0,0] row_mask:0xf bank_mask:0xf
  v_add_f32_dpp v77, v37, v77 quad_perm:[1,1,1,1] row_mask:0xf bank_mask:0xf
  v_add_f32_dpp v77, v38, v77 quad_perm:[2,2,2,2] row_mask:0xf bank_mask:0xf
  v_add_f32_dpp v77, v39, v77 quad_perm:[3,3,3,3] row_mask:0xf bank_mask:0xf
  v_mov_b32_dpp v78, v40 quad_perm:[0,0,0,0] row_mask:0xf bank_mask:0xf
  v_add_f32_dpp v78, v41, v78 quad_perm:[1,1,1,1] row_mask:0xf bank_mask:0xf
  v_add_f32_dpp v78, v42, v78 quad_perm:[2,2,2,2] row_mask:0xf bank_mask:0xf
  v_add_f32_dpp v78, v43, v78 quad_perm:[3,3,3,3] row_mask:0xf bank_mask:0xf
  v_mov_b32_dpp v79, v44 quad_perm:[0,0,0,0] row_mask:0xf bank_mask:0xf
  v_add_f32_dpp v79, v45, v79 quad_perm:[1,1,1,1] row_mask:0xf bank_mask:0xf
  v_add_f32_dpp v79, v46, v79 quad_perm:[2,2,2,2] row_mask:0xf bank_mask:0xf
  v_add_f32_dpp v79, v47, v79 quad_perm:[3,3,3,3] row_mask:0xf bank_mask:0xf
  v_cndmask_b32 v48, v76, v77, s[44:45]
  v_cndmask_b32 v48, v48, v78, s[46:47]
  v_cndmask_b32 v48, v48, v79, s[48:49]
  s_cmp_lg_u32 s3, 0
  s_cbranch_scc1 L_sig14
  s_waitcnt vmcnt(16)
  s_lshl_b32 s65, s63, 8
  s_add_u32 s65, s65, 1376256
  v_mov_b32 v84, s65
  v_mov_b32 v86, s79
  v_not_b32 v87, v86
  s_mov_b64 exec, 1
  global_store_dwordx2 v84, v[86:87], s[30:31] sc1
  s_mov_b64 exec, -1
L_sig14:
  s_waitcnt vmcnt(31)
  v_mfma_f32_16x16x32_bf16 v[32:35], v[188:191], v[16:19], 0
  global_load_dwordx4 v[188:191], v3, s[38:39] offset:-4096 nt
  s_waitcnt vmcnt(31)
  v_mfma_f32_16x16x32_bf16 v[32:35], v[192:195], v[20:23], v[32:35]
  global_load_dwordx4 v[192:195], v3, s[38:39] offset:-3072 nt
  s_waitcnt vmcnt(31)
  v_mfma_f32_16x16x32_bf16 v[32:35], v[196:199], v[24:27], v[32:35]
  global_load_dwordx4 v[196:199], v3, s[38:39] offset:-2048 nt
  s_waitcnt vmcnt(31)
  v_mfma_f32_16x16x32_bf16 v[32:35], v[200:203], v[28:31], v[32:35]
  global_load_dwordx4 v[200:203], v3, s[38:39] offset:-1024 nt
  s_waitcnt vmcnt(31)
  v_mfma_f32_16x16x32_bf16 v[36:39], v[204:207], v[16:19], 0
  global_load_dwordx4 v[204:207], v3, s[38:39] offset:0 nt
  s_waitcnt vmcnt(31)
  v_mfma_f32_16x16x32_bf16 v[36:39], v[208:211], v[20:23], v[36:39]
  global_load_dwordx4 v[208:211], v3, s[38:39] offset:1024 nt
  s_waitcnt vmcnt(31)
  v_mfma_f32_16x16x32_bf16 v[36:39], v[212:215], v[24:27], v[36:39]
  global_load_dwordx4 v[212:215], v3, s[38:39] offset:2048 nt
  s_waitcnt vmcnt(31)
  v_mfma_f32_16x16x32_bf16 v[36:39], v[216:219], v[28:31], v[36:39]
  global_load_dwordx4 v[216:219], v3, s[38:39] offset:3072 nt
  s_add_u32 s38, s38, 0x10000
  s_addc_u32 s39, s39, 0
  s_waitcnt vmcnt(31)
  v_mfma_f32_16x16x32_bf16 v[40:43], v[220:223], v[16:19], 0
  global_load_dwordx4 v[220:223], v3, s[38:39] offset:-4096 nt
  s_waitcnt vmcnt(31)
  v_mfma_f32_16x16x32_bf16 v[40:43], v[224:227], v[20:23], v[40:43]
  global_load_dwordx4 v[224:227], v3, s[38:39] offset:-3072 nt
  s_waitcnt vmcnt(31)
  v_mfma_f32_16x16x32_bf16 v[40:43], v[228:231], v[24:27], v[40:43]
  global_load_dwordx4 v[228:231], v3, s[38:39] offset:-2048 nt
  s_waitcnt vmcnt(31)
  v_mfma_f32_16x16x32_bf16 v[40:43], v[232:235], v[28:31], v[40:43]
  global_load_dwordx4 v[232:235], v3, s[38:39] offset:-1024 nt
  s_waitcnt vmcnt(31)
  v_mfma_f32_16x16x32_bf16 v[44:47], v[236:239], v[16:19], 0
  global_load_dwordx4 v[236:239], v3, s[38:39] offset:0 nt
  s_waitcnt vmcnt(31)
  v_mfma_f32_16x16x32_bf16 v[44:47], v[240:243], v[20:23], v[44:47]
  global_load_dwordx4 v[240:243], v3, s[38:39] offset:1024 nt
  s_waitcnt vmcnt(31)
  v_mfma_f32_16x16x32_bf16 v[44:47], v[244:247], v[24:27], v[44:47]
  global_load_dwordx4 v[244:247], v3, s[38:39] offset:2048 nt
  s_waitcnt vmcnt(31)
  v_mfma_f32_16x16x32_bf16 v[44:47], v[248:251], v[28:31], v[44:47]
  global_load_dwordx4 v[248:251], v3, s[38:39] offset:3072 nt
  s_add_u32 s38, s38, 0x10000
  s_addc_u32 s39, s39, 0
  s_nop 7
  v_mov_b32_dpp v76, v32 quad_perm:[0,0,0,0] row_mask:0xf bank_mask:0xf
  v_add_f32_dpp v76, v33, v76 quad_perm:[1,1,1,1] row_mask:0xf bank_mask:0xf
  v_add_f32_dpp v76, v34, v76 quad_perm:[2,2,2,2] row_mask:0xf bank_mask:0xf
  v_add_f32_dpp v76, v35, v76 quad_perm:[3,3,3,3] row_mask:0xf bank_mask:0xf
  v_mov_b32_dpp v77, v36 quad_perm:[0,0,0,0] row_mask:0xf bank_mask:0xf
  v_add_f32_dpp v77, v37, v77 quad_perm:[1,1,1,1] row_mask:0xf bank_mask:0xf
  v_add_f32_dpp v77, v38, v77 quad_perm:[2,2,2,2] row_mask:0xf bank_mask:0xf
  v_add_f32_dpp v77, v39, v77 quad_perm:[3,3,3,3] row_mask:0xf bank_mask:0xf
  v_mov_b32_dpp v78, v40 quad_perm:[0,0,0,0] row_mask:0xf bank_mask:0xf
  v_add_f32_dpp v78, v41, v78 quad_perm:[1,1,1,1] row_mask:0xf bank_mask:0xf
  v_add_f32_dpp v78, v42, v78 quad_perm:[2,2,2,2] row_mask:0xf bank_mask:0xf
  v_add_f32_dpp v78, v43, v78 quad_perm:[3,3,3,3] row_mask:0xf bank_mask:0xf
  v_mov_b32_dpp v79, v44 quad_perm:[0,0,0,0] row_mask:0xf bank_mask:0xf
  v_add_f32_dpp v79, v45, v79 quad_perm:[1,1,1,1] row_mask:0xf bank_mask:0xf
  v_add_f32_dpp v79, v46, v79 quad_perm:[2,2,2,2] row_mask:0xf bank_mask:0xf
  v_add_f32_dpp v79, v47, v79 quad_perm:[3,3,3,3] row_mask:0xf bank_mask:0xf
  v_cndmask_b32 v49, v76, v77, s[44:45]
  v_cndmask_b32 v49, v49, v78, s[46:47]
  v_cndmask_b32 v49, v49, v79, s[48:49]
  v_cvt_pk_bf16_f32 v48, v48, v48
  v_and_b32 v48, 0xffff0000, v48
  v_cvt_pk_bf16_f32 v49, v49, v49
  v_and_b32 v49, 0xffff0000, v49
  v_mul_f32 v48, v48, v13
  v_mul_f32 v49, v49, v13
  v_cvt_pk_bf16_f32 v48, v48, v48
  v_and_b32 v48, 0xffff0000, v48
  v_cvt_pk_bf16_f32 v49, v49, v49
  v_and_b32 v49, 0xffff0000, v49
  v_mul_f32 v48, v48, v12
  v_mul_f32 v49, v49, v12
  v_mov_b32 v76, v48
  v_max_f32 v76, v76, v49
  s_nop 1
  v_max_f32_dpp v76, v76, v76 row_ror:8 row_mask:0xf bank_mask:0xf
  s_nop 1
  v_max_f32_dpp v76, v76, v76 row_ror:4 row_mask:0xf bank_mask:0xf
  s_nop 1
  v_max_f32_dpp v76, v76, v76 row_ror:2 row_mask:0xf bank_mask:0xf
  s_nop 1
  v_max_f32_dpp v76, v76, v76 row_ror:1 row_mask:0xf bank_mask:0xf
  s_nop 1
  v_max_f32_dpp v76, v76, v76 row_bcast:15 row_mask:0xa bank_mask:0xf
  s_nop 1
  v_max_f32_dpp v76, v76, v76 row_bcast:31 row_mask:0xc bank_mask:0xf
  s_nop 0
  v_readlane_b32 s68, v76, 63
  s_nop 1
  v_subrev_f32 v48, s68, v48
  v_subrev_f32 v49, s68, v49
  v_exp_f32 v48, v48
  v_exp_f32 v49, v49
  s_nop 0
  v_cvt_pk_bf16_f32 v53, v48, v48
  v_cvt_pk_bf16_f32 v54, v49, v49
  v_mov_b32 v76, v48
  v_add_f32 v76, v76, v49
  s_nop 1
  v_add_f32_dpp v76, v76, v76 row_ror:8 row_mask:0xf bank_mask:0xf
  s_nop 1
  v_add_f32_dpp v76, v76, v76 row_ror:4 row_mask:0xf bank_mask:0xf
  s_nop 1
  v_add_f32_dpp v76, v76, v76 row_ror:2 row_mask:0xf bank_mask:0xf
  s_nop 1
  v_add_f32_dpp v76, v76, v76 row_ror:1 row_mask:0xf bank_mask:0xf
  s_nop 1
  v_add_f32_dpp v76, v76, v76 row_bcast:15 row_mask:0xa bank_mask:0xf
  s_nop 1
  v_add_f32_dpp v76, v76, v76 row_bcast:31 row_mask:0xc bank_mask:0xf
  s_nop 0
  v_readlane_b32 s69, v76, 63
  s_nop 1
  s_nop 1
  v_and_b32_dpp v60, v53, v6 row_newbcast:0 row_mask:0xf bank_mask:0xf
  v_and_b32_dpp v61, v53, v7 row_newbcast:0 row_mask:0xf bank_mask:0xf
  v_and_b32_dpp v62, v53, v8 row_newbcast:0 row_mask:0xf bank_mask:0xf
  v_and_b32_dpp v63, v53, v9 row_newbcast:0 row_mask:0xf bank_mask:0xf
  v_and_b32_dpp v64, v53, v6 row_newbcast:4 row_mask:0xf bank_mask:0xf
  v_and_b32_dpp v65, v53, v7 row_newbcast:4 row_mask:0xf bank_mask:0xf
  v_and_b32_dpp v66, v53, v8 row_newbcast:4 row_mask:0xf bank_mask:0xf
  v_and_b32_dpp v67, v53, v9 row_newbcast:4 row_mask:0xf bank_mask:0xf
  s_waitcnt vmcnt(31)
  v_mfma_f32_16x16x32_bf16 v[68:71], v[60:63], v[124:127], 0
  v_and_b32_dpp v60, v53, v6 row_newbcast:8 row_mask:0xf bank_mask:0xf
  v_and_b32_dpp v61, v53, v7 row_newbcast:8 row_mask:0xf bank_mask:0xf
  v_and_b32_dpp v62, v53, v8 row_newbcast:8 row_mask:0xf bank_mask:0xf
  v_and_b32_dpp v63, v53, v9 row_newbcast:8 row_mask:0xf bank_mask:0xf
  s_waitcnt vmcnt(30)
  v_mfma_f32_16x16x32_bf16 v[68:71], v[64:67], v[128:131], v[68:71]
  v_and_b32_dpp v64, v53, v6 row_newbcast:12 row_mask:0xf bank_mask:0xf
  v_and_b32_dpp v65, v53, v7 row_newbcast:12 row_mask:0xf bank_mask:0xf
  v_and_b32_dpp v66, v53, v8 row_newbcast:12 row_mask:0xf bank_mask:0xf
  v_and_b32_dpp v67, v53, v9 row_newbcast:12 row_mask:0xf bank_mask:0xf
  s_waitcnt vmcnt(29)
  v_mfma_f32_16x16x32_bf16 v[68:71], v[60:63], v[132:135], v[68:71]
  v_and_b32_dpp v60, v53, v6 row_newbcast:1 row_mask:0xf bank_mask:0xf
  v_and_b32_dpp v61, v53, v7 row_newbcast:1 row_mask:0xf bank_mask:0xf
  v_and_b32_dpp v62, v53, v8 row_newbcast:1 row_mask:0xf bank_mask:0xf
  v_and_b32_dpp v63, v53, v9 row_newbcast:1 row_mask:0xf bank_mask:0xf
  s_waitcnt vmcnt(28)
  v_mfma_f32_16x16x32_bf16 v[68:71], v[64:67], v[136:139], v[68:71]
  v_and_b32_dpp v64, v53, v6 row_newbcast:5 row_mask:0xf bank_mask:0xf
  v_and_b32_dpp v65, v53, v7 row_newbcast:5 row_mask:0xf bank_mask:0xf
  v_and_b32_dpp v66, v53, v8 row_newbcast:5 row_mask:0xf bank_mask:0xf
  v_and_b32_dpp v67, v53, v9 row_newbcast:5 row_mask:0xf bank_mask:0xf
  s_waitcnt vmcnt(27)
  v_mfma_f32_16x16x32_bf16 v[68:71], v[60:63], v[140:143], v[68:71]
  v_and_b32_dpp v60, v53, v6 row_newbcast:9 row_mask:0xf bank_mask:0xf
  v_and_b32_dpp v61, v53, v7 row_newbcast:9 row_mask:0xf bank_mask:0xf
  v_and_b32_dpp v62, v53, v8 row_newbcast:9 row_mask:0xf bank_mask:0xf
  v_and_b32_dpp v63, v53, v9 row_newbcast:9 row_mask:0xf bank_mask:0xf
  s_waitcnt vmcnt(26)
  v_mfma_f32_16x16x32_bf16 v[68:71], v[64:67], v[144:147], v[68:71]
  v_and_b32_dpp v64, v53, v6 row_newbcast:13 row_mask:0xf bank_mask:0xf
  v_and_b32_dpp v65, v53, v7 row_newbcast:13 row_mask:0xf bank_mask:0xf
  v_and_b32_dpp v66, v53, v8 row_newbcast:13 row_mask:0xf bank_mask:0xf
  v_and_b32_dpp v67, v53, v9 row_newbcast:13 row_mask:0xf bank_mask:0xf
  s_waitcnt vmcnt(25)
  v_mfma_f32_16x16x32_bf16 v[68:71], v[60:63], v[148:151], v[68:71]
  v_and_b32_dpp v60, v53, v6 row_newbcast:2 row_mask:0xf bank_mask:0xf
  v_and_b32_dpp v61, v53, v7 row_newbcast:2 row_mask:0xf bank_mask:0xf
  v_and_b32_dpp v62, v53, v8 row_newbcast:2 row_mask:0xf bank_mask:0xf
  v_and_b32_dpp v63, v53, v9 row_newbcast:2 row_mask:0xf bank_mask:0xf
  s_waitcnt vmcnt(24)
  v_mfma_f32_16x16x32_bf16 v[68:71], v[64:67], v[152:155], v[68:71]
  v_and_b32_dpp v64, v53, v6 row_newbcast:6 row_mask:0xf bank_mask:0xf
  v_and_b32_dpp v65, v53, v7 row_newbcast:6 row_mask:0xf bank_mask:0xf
  v_and_b32_dpp v66, v53, v8 row_newbcast:6 row_mask:0xf bank_mask:0xf
  v_and_b32_dpp v67, v53, v9 row_newbcast:6 row_mask:0xf bank_mask:0xf
  s_waitcnt vmcnt(23)
  v_mfma_f32_16x16x32_bf16 v[68:71], v[60:63], v[156:159], v[68:71]
  v_and_b32_dpp v60, v53, v6 row_newbcast:10 row_mask:0xf bank_mask:0xf
  v_and_b32_dpp v61, v53, v7 row_newbcast:10 row_mask:0xf bank_mask:0xf
  v_and_b32_dpp v62, v53, v8 row_newbcast:10 row_mask:0xf bank_mask:0xf
  v_and_b32_dpp v63, v53, v9 row_newbcast:10 row_mask:0xf bank_mask:0xf
  s_waitcnt vmcnt(22)
  v_mfma_f32_16x16x32_bf16 v[68:71], v[64:67], v[160:163], v[68:71]
  v_and_b32_dpp v64, v53, v6 row_newbcast:14 row_mask:0xf bank_mask:0xf
  v_and_b32_dpp v65, v53, v7 row_newbcast:14 row_mask:0xf bank_mask:0xf
  v_and_b32_dpp v66, v53, v8 row_newbcast:14 row_mask:0xf bank_mask:0xf
  v_and_b32_dpp v67, v53, v9 row_newbcast:14 row_mask:0xf bank_mask:0xf
  s_waitcnt vmcnt(21)
  v_mfma_f32_16x16x32_bf16 v[68:71], v[60:63], v[164:167], v[68:71]
  v_and_b32_dpp v60, v53, v6 row_newbcast:3 row_mask:0xf bank_mask:0xf
  v_and_b32_dpp v61, v53, v7 row_newbcast:3 row_mask:0xf bank_mask:0xf
  v_and_b32_dpp v62, v53, v8 row_newbcast:3 row_mask:0xf bank_mask:0xf
  v_and_b32_dpp v63, v53, v9 row_newbcast:3 row_mask:0xf bank_mask:0xf
  s_waitcnt vmcnt(20)
  v_mfma_f32_16x16x32_bf16 v[68:71], v[64:67], v[168:171], v[68:71]
  v_and_b32_dpp v64, v53, v6 row_newbcast:7 row_mask:0xf bank_mask:0xf
  v_and_b32_dpp v65, v53, v7 row_newbcast:7 row_mask:0xf bank_mask:0xf
  v_and_b32_dpp v66, v53, v8 row_newbcast:7 row_mask:0xf bank_mask:0xf
  v_and_b32_dpp v67, v53, v9 row_newbcast:7 row_mask:0xf bank_mask:0xf
  s_waitcnt vmcnt(19)
  v_mfma_f32_16x16x32_bf16 v[68:71], v[60:63], v[172:175], v[68:71]
  v_and_b32_dpp v60, v53, v6 row_newbcast:11 row_mask:0xf bank_mask:0xf
  v_and_b32_dpp v61, v53, v7 row_newbcast:11 row_mask:0xf bank_mask:0xf
  v_and_b32_dpp v62, v53, v8 row_newbcast:11 row_mask:0xf bank_mask:0xf
  v_and_b32_dpp v63, v53, v9 row_newbcast:11 row_mask:0xf bank_mask:0xf
  s_waitcnt vmcnt(18)
  v_mfma_f32_16x16x32_bf16 v[68:71], v[64:67], v[176:179], v[68:71]
  v_and_b32_dpp v64, v53, v6 row_newbcast:15 row_mask:0xf bank_mask:0xf
  v_and_b32_dpp v65, v53, v7 row_newbcast:15 row_mask:0xf bank_mask:0xf
  v_and_b32_dpp v66, v53, v8 row_newbcast:15 row_mask:0xf bank_mask:0xf
  v_and_b32_dpp v67, v53, v9 row_newbcast:15 row_mask:0xf bank_mask:0xf
  s_waitcnt vmcnt(17)
  v_mfma_f32_16x16x32_bf16 v[68:71], v[60:63], v[180:183], v[68:71]
  s_nop 0
  s_waitcnt vmcnt(16)
  v_mfma_f32_16x16x32_bf16 v[68:71], v[64:67], v[184:187], v[68:71]
  s_nop 1
  v_and_b32_dpp v60, v54, v6 row_newbcast:0 row_mask:0xf bank_mask:0xf
  v_and_b32_dpp v61, v54, v7 row_newbcast:0 row_mask:0xf bank_mask:0xf
  v_and_b32_dpp v62, v54, v8 row_newbcast:0 row_mask:0xf bank_mask:0xf
  v_and_b32_dpp v63, v54, v9 row_newbcast:0 row_mask:0xf bank_mask:0xf
  v_and_b32_dpp v64, v54, v6 row_newbcast:4 row_mask:0xf bank_mask:0xf
  v_and_b32_dpp v65, v54, v7 row_newbcast:4 row_mask:0xf bank_mask:0xf
  v_and_b32_dpp v66, v54, v8 row_newbcast:4 row_mask:0xf bank_mask:0xf
  v_and_b32_dpp v67, v54, v9 row_newbcast:4 row_mask:0xf bank_mask:0xf
  s_waitcnt vmcnt(15)
  v_mfma_f32_16x16x32_bf16 v[68:71], v[60:63], v[188:191], v[68:71]
  v_and_b32_dpp v60, v54, v6 row_newbcast:8 row_mask:0xf bank_mask:0xf
  v_and_b32_dpp v61, v54, v7 row_newbcast:8 row_mask:0xf bank_mask:0xf
  v_and_b32_dpp v62, v54, v8 row_newbcast:8 row_mask:0xf bank_mask:0xf
  v_and_b32_dpp v63, v54, v9 row_newbcast:8 row_mask:0xf bank_mask:0xf
  s_waitcnt vmcnt(14)
  v_mfma_f32_16x16x32_bf16 v[68:71], v[64:67], v[192:195], v[68:71]
  s_lshl_b32 s64, s3, 14
  v_add_u32 v14, s64, v3
  ds_read_b128 v[188:191], v14 offset:0
  v_and_b32_dpp v64, v54, v6 row_newbcast:12 row_mask:0xf bank_mask:0xf
  v_and_b32_dpp v65, v54, v7 row_newbcast:12 row_mask:0xf bank_mask:0xf
  v_and_b32_dpp v66, v54, v8 row_newbcast:12 row_mask:0xf bank_mask:0xf
  v_and_b32_dpp v67, v54, v9 row_newbcast:12 row_mask:0xf bank_mask:0xf
  s_waitcnt vmcnt(13)
  v_mfma_f32_16x16x32_bf16 v[68:71], v[60:63], v[196:199], v[68:71]
  ds_read_b128 v[192:195], v14 offset:1024
  v_and_b32_dpp v60, v54, v6 row_newbcast:1 row_mask:0xf bank_mask:0xf
  v_and_b32_dpp v61, v54, v7 row_newbcast:1 row_mask:0xf bank_mask:0xf
  v_and_b32_dpp v62, v54, v8 row_newbcast:1 row_mask:0xf bank_mask:0xf
  v_and_b32_dpp v63, v54, v9 row_newbcast:1 row_mask:0xf bank_mask:0xf
  s_waitcnt vmcnt(12)
  v_mfma_f32_16x16x32_bf16 v[68:71], v[64:67], v[200:203], v[68:71]
  ds_read_b128 v[196:199], v14 offset:2048
  v_and_b32_dpp v64, v54, v6 row_newbcast:5 row_mask:0xf bank_mask:0xf
  v_and_b32_dpp v65, v54, v7 row_newbcast:5 row_mask:0xf bank_mask:0xf
  v_and_b32_dpp v66, v54, v8 row_newbcast:5 row_mask:0xf bank_mask:0xf
  v_and_b32_dpp v67, v54, v9 row_newbcast:5 row_mask:0xf bank_mask:0xf
  s_waitcnt vmcnt(11)
  v_mfma_f32_16x16x32_bf16 v[68:71], v[60:63], v[204:207], v[68:71]
  ds_read_b128 v[200:203], v14 offset:3072
  v_and_b32_dpp v60, v54, v6 row_newbcast:9 row_mask:0xf bank_mask:0xf
  v_and_b32_dpp v61, v54, v7 row_newbcast:9 row_mask:0xf bank_mask:0xf
  v_and_b32_dpp v62, v54, v8 row_newbcast:9 row_mask:0xf bank_mask:0xf
  v_and_b32_dpp v63, v54, v9 row_newbcast:9 row_mask:0xf bank_mask:0xf
  s_waitcnt vmcnt(10)
  v_mfma_f32_16x16x32_bf16 v[68:71], v[64:67], v[208:211], v[68:71]
  ds_read_b128 v[204:207], v14 offset:4096
  v_and_b32_dpp v64, v54, v6 row_newbcast:13 row_mask:0xf bank_mask:0xf
  v_and_b32_dpp v65, v54, v7 row_newbcast:13 row_mask:0xf bank_mask:0xf
  v_and_b32_dpp v66, v54, v8 row_newbcast:13 row_mask:0xf bank_mask:0xf
  v_and_b32_dpp v67, v54, v9 row_newbcast:13 row_mask:0xf bank_mask:0xf
  s_waitcnt vmcnt(9)
  v_mfma_f32_16x16x32_bf16 v[68:71], v[60:63], v[212:215], v[68:71]
  ds_read_b128 v[208:211], v14 offset:5120
  v_and_b32_dpp v60, v54, v6 row_newbcast:2 row_mask:0xf bank_mask:0xf
  v_and_b32_dpp v61, v54, v7 row_newbcast:2 row_mask:0xf bank_mask:0xf
  v_and_b32_dpp v62, v54, v8 row_newbcast:2 row_mask:0xf bank_mask:0xf
  v_and_b32_dpp v63, v54, v9 row_newbcast:2 row_mask:0xf bank_mask:0xf
  s_waitcnt vmcnt(8)
  v_mfma_f32_16x16x32_bf16 v[68:71], v[64:67], v[216:219], v[68:71]
  ds_read_b128 v[212:215], v14 offset:6144
  v_and_b32_dpp v64, v54, v6 row_newbcast:6 row_mask:0xf bank_mask:0xf
  v_and_b32_dpp v65, v54, v7 row_newbcast:6 row_mask:0xf bank_mask:0xf
  v_and_b32_dpp v66, v54, v8 row_newbcast:6 row_mask:0xf bank_mask:0xf
  v_and_b32_dpp v67, v54, v9 row_newbcast:6 row_mask:0xf bank_mask:0xf
  s_waitcnt vmcnt(7)
  v_mfma_f32_16x16x32_bf16 v[68:71], v[60:63], v[220:223], v[68:71]
  ds_read_b128 v[216:219], v14 offset:7168
  v_and_b32_dpp v60, v54, v6 row_newbcast:10 row_mask:0xf bank_mask:0xf
  v_and_b32_dpp v61, v54, v7 row_newbcast:10 row_mask:0xf bank_mask:0xf
  v_and_b32_dpp v62, v54, v8 row_newbcast:10 row_mask:0xf bank_mask:0xf
  v_and_b32_dpp v63, v54, v9 row_newbcast:10 row_mask:0xf bank_mask:0xf
  s_waitcnt vmcnt(6)
  v_mfma_f32_16x16x32_bf16 v[68:71], v[64:67], v[224:227], v[68:71]
  ds_read_b128 v[220:223], v14 offset:8192
  v_and_b32_dpp v64, v54, v6 row_newbcast:14 row_mask:0xf bank_mask:0xf
  v_and_b32_dpp v65, v54, v7 row_newbcast:14 row_mask:0xf bank_mask:0xf
  v_and_b32_dpp v66, v54, v8 row_newbcast:14 row_mask:0xf bank_mask:0xf
  v_and_b32_dpp v67, v54, v9 row_newbcast:14 row_mask:0xf bank_mask:0xf
  s_waitcnt vmcnt(5)
  v_mfma_f32_16x16x32_bf16 v[68:71], v[60:63], v[228:231], v[68:71]
  ds_read_b128 v[224:227], v14 offset:9216
  v_and_b32_dpp v60, v54, v6 row_newbcast:3 row_mask:0xf bank_mask:0xf
  v_and_b32_dpp v61, v54, v7 row_newbcast:3 row_mask:0xf bank_mask:0xf
  v_and_b32_dpp v62, v54, v8 row_newbcast:3 row_mask:0xf bank_mask:0xf
  v_and_b32_dpp v63, v54, v9 row_newbcast:3 row_mask:0xf bank_mask:0xf
  s_waitcnt vmcnt(4)
  v_mfma_f32_16x16x32_bf16 v[68:71], v[64:67], v[232:235], v[68:71]
  ds_read_b128 v[228:231], v14 offset:10240
  v_and_b32_dpp v64, v54, v6 row_newbcast:7 row_mask:0xf bank_mask:0xf
  v_and_b32_dpp v65, v54, v7 row_newbcast:7 row_mask:0xf bank_mask:0xf
  v_and_b32_dpp v66, v54, v8 row_newbcast:7 row_mask:0xf bank_mask:0xf
  v_and_b32_dpp v67, v54, v9 row_newbcast:7 row_mask:0xf bank_mask:0xf
  s_waitcnt vmcnt(3)
  v_mfma_f32_16x16x32_bf16 v[68:71], v[60:63], v[236:239], v[68:71]
  ds_read_b128 v[232:235], v14 offset:11264
  v_and_b32_dpp v60, v54, v6 row_newbcast:11 row_mask:0xf bank_mask:0xf
  v_and_b32_dpp v61, v54, v7 row_newbcast:11 row_mask:0xf bank_mask:0xf
  v_and_b32_dpp v62, v54, v8 row_newbcast:11 row_mask:0xf bank_mask:0xf
  v_and_b32_dpp v63, v54, v9 row_newbcast:11 row_mask:0xf bank_mask:0xf
  s_waitcnt vmcnt(2)
  v_mfma_f32_16x16x32_bf16 v[68:71], v[64:67], v[240:243], v[68:71]
  ds_read_b128 v[236:239], v14 offset:12288
  v_and_b32_dpp v64, v54, v6 row_newbcast:15 row_mask:0xf bank_mask:0xf
  v_and_b32_dpp v65, v54, v7 row_newbcast:15 row_mask:0xf bank_mask:0xf
  v_and_b32_dpp v66, v54, v8 row_newbcast:15 row_mask:0xf bank_mask:0xf
  v_and_b32_dpp v67, v54, v9 row_newbcast:15 row_mask:0xf bank_mask:0xf
  s_waitcnt vmcnt(1)
  v_mfma_f32_16x16x32_bf16 v[68:71], v[60:63], v[244:247], v[68:71]
  ds_read_b128 v[240:243], v14 offset:13312
  s_nop 0
  s_waitcnt vmcnt(0)
  v_mfma_f32_16x16x32_bf16 v[68:71], v[64:67], v[248:251], v[68:71]
  ds_read_b128 v[244:247], v14 offset:14336
  v_and_b32 v76, 1, v11
  v_lshlrev_b32 v76, 4, v76
  v_lshl_add_u32 v76, v10, 5, v76
  s_lshl_b32 s64, s3, 9
  s_add_u32 s64, s64, 152704
  v_add_u32 v76, s64, v76
  s_lshl_b32 s64, s3, 3
  s_add_u32 s64, s64, 157312
  v_mov_b32 v77, s64
  v_mov_b32 v78, s68
  v_mov_b32 v79, s69
  ds_write_b64 v77, v[78:79]
  s_nop 3
  ds_write_b128 v76, v[68:71]
  s_waitcnt lgkmcnt(0)
  s_barrier
  v_mov_b32 v114, 157312
  ds_read_b128 v[76:79], v114 offset:0
  ds_read_b128 v[80:83], v114 offset:16
  ds_read_b128 v[84:87], v114 offset:32
  ds_read_b128 v[88:91], v114 offset:48
  v_lshl_add_u32 v115, v10, 3, v11
  v_lshlrev_b32 v115, 2, v115
  v_add_u32 v115, 152704, v115
  ds_read_b32 v96, v115 offset:0
  ds_read_b32 v97, v115 offset:16
  ds_read_b32 v98, v115 offset:512
  ds_read_b32 v99, v115 offset:528
  ds_read_b32 v100, v115 offset:1024
  ds_read_b32 v101, v115 offset:1040
  ds_read_b32 v102, v115 offset:1536
  ds_read_b32 v103, v115 offset:1552
  ds_read_b32 v104, v115 offset:2048
  ds_read_b32 v105, v115 offset:2064
  ds_read_b32 v106, v115 offset:2560
  ds_read_b32 v107, v115 offset:2576
  ds_read_b32 v108, v115 offset:3072
  ds_read_b32 v109, v115 offset:3088
  ds_read_b32 v110, v115 offset:3584
  ds_read_b32 v111, v115 offset:3600
  s_waitcnt lgkmcnt(0)
  v_max_f32 v117, v76, v78
  v_max_f32 v117, v117, v80
  v_max_f32 v117, v117, v82
  v_max_f32 v117, v117, v84
  v_max_f32 v117, v117, v86
  v_max_f32 v117, v117, v88
  v_max_f32 v117, v117, v90
  v_sub_f32 v76, v76, v117
  v_sub_f32 v78, v78, v117
  v_sub_f32 v80, v80, v117
  v_sub_f32 v82, v82, v117
  v_sub_f32 v84, v84, v117
  v_sub_f32 v86, v86, v117
  v_sub_f32 v88, v88, v117
  v_sub_f32 v90, v90, v117
  v_exp_f32 v76, v76
  v_exp_f32 v78, v78
  v_exp_f32 v80, v80
  v_exp_f32 v82, v82
  v_exp_f32 v84, v84
  v_exp_f32 v86, v86
  v_exp_f32 v88, v88
  v_exp_f32 v90, v90
  s_nop 0
  v_mul_f32 v118, v76, v77
  v_fmac_f32 v118, v78, v79
  v_fmac_f32 v118, v80, v81
  v_fmac_f32 v118, v82, v83
  v_fmac_f32 v118, v84, v85
  v_fmac_f32 v118, v86, v87
  v_fmac_f32 v118, v88, v89
  v_fmac_f32 v118, v90, v91
  v_rcp_f32 v114, v118
  v_mul_f32 v115, v76, v96
  v_mul_f32 v116, v76, v97
  v_fmac_f32 v115, v78, v98
  v_fmac_f32 v116, v78, v99
  v_fmac_f32 v115, v80, v100
  v_fmac_f32 v116, v80, v101
  v_fmac_f32 v115, v82, v102
  v_fmac_f32 v116, v82, v103
  v_fmac_f32 v115, v84, v104
  v_fmac_f32 v116, v84, v105
  v_fmac_f32 v115, v86, v106
  v_fmac_f32 v116, v86, v107
  v_fmac_f32 v115, v88, v108
  v_fmac_f32 v116, v88, v109
  v_fmac_f32 v115, v90, v110
  v_fmac_f32 v116, v90, v111
  v_mul_f32 v115, v115, v114
  v_mul_f32 v116, v116, v114
L_tail:
  v_cvt_pk_bf16_f32 v53, v115, v115
  v_cvt_pk_bf16_f32 v54, v116, v116
  ds_read_b128 v[248:251], v14 offset:15360
  s_nop 0
  v_mov_b32_dpp v120, v53 row_newbcast:0 row_mask:0xf bank_mask:0xf
  v_mov_b32_dpp v121, v54 row_newbcast:0 row_mask:0xf bank_mask:0xf
  v_cndmask_b32 v120, v120, v121, s[58:59]
  v_and_b32 v60, v120, v6
  v_and_b32 v61, v120, v7
  v_and_b32 v62, v120, v8
  v_and_b32 v63, v120, v9
  v_mov_b32_dpp v120, v53 row_newbcast:1 row_mask:0xf bank_mask:0xf
  v_mov_b32_dpp v121, v54 row_newbcast:1 row_mask:0xf bank_mask:0xf
  v_cndmask_b32 v120, v120, v121, s[58:59]
  v_and_b32 v64, v120, v6
  v_and_b32 v65, v120, v7
  v_and_b32 v66, v120, v8
  v_and_b32 v67, v120, v9
  v_mfma_f32_16x16x32_bf16 v[68:71], v[60:63], v[188:191], 0
  v_mov_b32_dpp v120, v53 row_newbcast:2 row_mask:0xf bank_mask:0xf
  v_mov_b32_dpp v121, v54 row_newbcast:2 row_mask:0xf bank_mask:0xf
  v_cndmask_b32 v120, v120, v121, s[58:59]
  v_and_b32 v60, v120, v6
  v_and_b32 v61, v120, v7
  v_and_b32 v62, v120, v8
  v_and_b32 v63, v120, v9
  v_mfma_f32_16x16x32_bf16 v[68:71], v[64:67], v[192:195], v[68:71]
  v_mov_b32_dpp v120, v53 row_newbcast:3 row_mask:0xf bank_mask:0xf
  v_mov_b32_dpp v121, v54 row_newbcast:3 row_mask:0xf bank_mask:0xf
  v_cndmask_b32 v120, v120, v121, s[58:59]
  v_and_b32 v64, v120, v6
  v_and_b32 v65, v120, v7
  v_and_b32 v66, v120, v8
  v_and_b32 v67, v120, v9
  v_mfma_f32_16x16x32_bf16 v[68:71], v[60:63], v[196:199], v[68:71]
  v_mov_b32_dpp v120, v53 row_newbcast:4 row_mask:0xf bank_mask:0xf
  v_mov_b32_dpp v121, v54 row_newbcast:4 row_mask:0xf bank_mask:0xf
  v_cndmask_b32 v120, v120, v121, s[58:59]
  v_and_b32 v60, v120, v6
  v_and_b32 v61, v120, v7
  v_and_b32 v62, v120, v8
  v_and_b32 v63, v120, v9
  v_mfma_f32_16x16x32_bf16 v[68:71], v[64:67], v[200:203], v[68:71]
  v_mov_b32_dpp v120, v53 row_newbcast:5 row_mask:0xf bank_mask:0xf
  v_mov_b32_dpp v121, v54 row_newbcast:5 row_mask:0xf bank_mask:0xf
  v_cndmask_b32 v120, v120, v121, s[58:59]
  v_and_b32 v64, v120, v6
  v_and_b32 v65, v120, v7
  v_and_b32 v66, v120, v8
  v_and_b32 v67, v120, v9
  v_mfma_f32_16x16x32_bf16 v[68:71], v[60:63], v[204:207], v[68:71]
  v_mov_b32_dpp v120, v53 row_newbcast:6 row_mask:0xf bank_mask:0xf
  v_mov_b32_dpp v121, v54 row_newbcast:6 row_mask:0xf bank_mask:0xf
  v_cndmask_b32 v120, v120, v121, s[58:59]
  v_and_b32 v60, v120, v6
  v_and_b32 v61, v120, v7
  v_and_b32 v62, v120, v8
  v_and_b32 v63, v120, v9
  v_mfma_f32_16x16x32_bf16 v[68:71], v[64:67], v[208:211], v[68:71]
  v_mov_b32_dpp v120, v53 row_newbcast:7 row_mask:0xf bank_mask:0xf
  v_mov_b32_dpp v121, v54 row_newbcast:7 row_mask:0xf bank_mask:0xf
  v_cndmask_b32 v120, v120, v121, s[58:59]
  v_and_b32 v64, v120, v6
  v_and_b32 v65, v120, v7
  v_and_b32 v66, v120, v8
  v_and_b32 v67, v120, v9
  v_mfma_f32_16x16x32_bf16 v[68:71], v[60:63], v[212:215], v[68:71]
  v_mov_b32_dpp v120, v53 row_newbcast:8 row_mask:0xf bank_mask:0xf
  v_mov_b32_dpp v121, v54 row_newbcast:8 row_mask:0xf bank_mask:0xf
  v_cndmask_b32 v120, v120, v121, s[58:59]
  v_and_b32 v60, v120, v6
  v_and_b32 v61, v120, v7
  v_and_b32 v62, v120, v8
  v_and_b32 v63, v120, v9
  v_mfma_f32_16x16x32_bf16 v[68:71], v[64:67], v[216:219], v[68:71]
  v_mov_b32_dpp v120, v53 row_newbcast:9 row_mask:0xf bank_mask:0xf
  v_mov_b32_dpp v121, v54 row_newbcast:9 row_mask:0xf bank_mask:0xf
  v_cndmask_b32 v120, v120, v121, s[58:59]
  v_and_b32 v64, v120, v6
  v_and_b32 v65, v120, v7
  v_and_b32 v66, v120, v8
  v_and_b32 v67, v120, v9
  v_mfma_f32_16x16x32_bf16 v[68:71], v[60:63], v[220:223], v[68:71]
  v_mov_b32_dpp v120, v53 row_newbcast:10 row_mask:0xf bank_mask:0xf
  v_mov_b32_dpp v121, v54 row_newbcast:10 row_mask:0xf bank_mask:0xf
  v_cndmask_b32 v120, v120, v121, s[58:59]
  v_and_b32 v60, v120, v6
  v_and_b32 v61, v120, v7
  v_and_b32 v62, v120, v8
  v_and_b32 v63, v120, v9
  v_mfma_f32_16x16x32_bf16 v[68:71], v[64:67], v[224:227], v[68:71]
  v_mov_b32_dpp v120, v53 row_newbcast:11 row_mask:0xf bank_mask:0xf
  v_mov_b32_dpp v121, v54 row_newbcast:11 row_mask:0xf bank_mask:0xf
  v_cndmask_b32 v120, v120, v121, s[58:59]
  v_and_b32 v64, v120, v6
  v_and_b32 v65, v120, v7
  v_and_b32 v66, v120, v8
  v_and_b32 v67, v120, v9
  v_mfma_f32_16x16x32_bf16 v[68:71], v[60:63], v[228:231], v[68:71]
  v_mov_b32_dpp v120, v53 row_newbcast:12 row_mask:0xf bank_mask:0xf
  v_mov_b32_dpp v121, v54 row_newbcast:12 row_mask:0xf bank_mask:0xf
  v_cndmask_b32 v120, v120, v121, s[58:59]
  v_and_b32 v60, v120, v6
  v_and_b32 v61, v120, v7
  v_and_b32 v62, v120, v8
  v_and_b32 v63, v120, v9
  v_mfma_f32_16x16x32_bf16 v[68:71], v[64:67], v[232:235], v[68:71]
  v_mov_b32_dpp v120, v53 row_newbcast:13 row_mask:0xf bank_mask:0xf
  v_mov_b32_dpp v121, v54 row_newbcast:13 row_mask:0xf bank_mask:0xf
  v_cndmask_b32 v120, v120, v121, s[58:59]
  v_and_b32 v64, v120, v6
  v_and_b32 v65, v120, v7
  v_and_b32 v66, v120, v8
  v_and_b32 v67, v120, v9
  v_mfma_f32_16x16x32_bf16 v[68:71], v[60:63], v[236:239], v[68:71]
  v_mov_b32_dpp v120, v53 row_newbcast:14 row_mask:0xf bank_mask:0xf
  v_mov_b32_dpp v121, v54 row_newbcast:14 row_mask:0xf bank_mask:0xf
  v_cndmask_b32 v120, v120, v121, s[58:59]
  v_and_b32 v60, v120, v6
  v_and_b32 v61, v120, v7
  v_and_b32 v62, v120, v8
  v_and_b32 v63, v120, v9
  v_mfma_f32_16x16x32_bf16 v[68:71], v[64:67], v[240:243], v[68:71]
  v_mov_b32_dpp v120, v53 row_newbcast:15 row_mask:0xf bank_mask:0xf
  v_mov_b32_dpp v121, v54 row_newbcast:15 row_mask:0xf bank_mask:0xf
  v_cndmask_b32 v120, v120, v121, s[58:59]
  v_and_b32 v64, v120, v6
  v_and_b32 v65, v120, v7
  v_and_b32 v66, v120, v8
  v_and_b32 v67, v120, v9
  v_mfma_f32_16x16x32_bf16 v[68:71], v[60:63], v[244:247], v[68:71]
  s_waitcnt lgkmcnt(0)
  v_mfma_f32_16x16x32_bf16 v[68:71], v[64:67], v[248:251], v[68:71]
  s_lshl_b32 s64, s61, 1
  s_add_u32 s64, s64, s62
  s_lshl_b32 s64, s64, 5
  s_add_u32 s64, s64, s60
  s_lshl_b32 s64, s64, 11
  s_lshl_b32 s65, s3, 8
  s_add_u32 s64, s64, s65
  v_lshlrev_b32 v84, 5, v10
  v_lshl_add_u32 v84, v11, 4, v84
  v_add_u32 v84, s64, v84
  v_mov_b32 v76, 0
  v_mov_b32 v77, 0
  v_mov_b32 v78, 0
  v_mov_b32 v79, 0
  s_nop 1
  v_permlane32_swap_b32 v68, v76
  v_permlane32_swap_b32 v69, v77
  v_permlane32_swap_b32 v70, v78
  v_permlane32_swap_b32 v71, v79
  s_nop 1
  v_add_f32_dpp v80, v76, v68 row_shl:8 row_mask:0xf bank_mask:0xf
  v_add_f32_dpp v81, v77, v69 row_shl:8 row_mask:0xf bank_mask:0xf
  v_add_f32_dpp v82, v78, v70 row_shl:8 row_mask:0xf bank_mask:0xf
  v_add_f32_dpp v83, v79, v71 row_shl:8 row_mask:0xf bank_mask:0xf
  v_mov_b32 v85, 0x7fc00000
  v_cmp_eq_u32 vcc, -1, v80
  s_nop 1
  v_cndmask_b32 v80, v80, v85, vcc
  v_cmp_eq_u32 vcc, -1, v81
  s_nop 1
  v_cndmask_b32 v81, v81, v85, vcc
  v_cmp_eq_u32 vcc, -1, v82
  s_nop 1
  v_cndmask_b32 v82, v82, v85, vcc
  v_cmp_eq_u32 vcc, -1, v83
  s_nop 1
  v_cndmask_b32 v83, v83, v85, vcc
  s_mov_b32 exec_lo, 0x00ff00ff
  s_mov_b32 exec_hi, 0
  global_store_dwordx4 v84, v[80:83], s[30:31] sc1
  s_mov_b64 exec, -1
  s_cmp_lg_u32 s3, 0
  s_cbranch_scc1 L_end
  s_lshl_b32 s64, s62, 5
  s_add_u32 s64, s64, s60
  s_lshl_b32 s65, s61, 17
  s_lshl_b32 s66, s64, 5
  s_add_u32 s65, s65, s66
  v_lshrrev_b32 v14, 3, v1
  v_lshlrev_b32 v14, 14, v14
  v_and_b32 v97, 7, v1
  v_lshl_add_u32 v14, v97, 2, v14
  v_add_u32 v14, s65, v14
  v_add_u32 v98, 4096, v14
  v_add_u32 v99, 8192, v14
  v_add_u32 v100, 12288, v14
  s_mov_b32 s78, 0
L_fpoll15:
  global_load_dword v88, v14, s[30:31] offset:0 sc1
  global_load_dword v89, v14, s[30:31] offset:2048 sc1
  global_load_dword v90, v98, s[30:31] offset:0 sc1
  global_load_dword v91, v98, s[30:31] offset:2048 sc1
  global_load_dword v92, v99, s[30:31] offset:0 sc1
  global_load_dword v93, v99, s[30:31] offset:2048 sc1
  global_load_dword v94, v100, s[30:31] offset:0 sc1
  global_load_dword v95, v100, s[30:31] offset:2048 sc1
  s_waitcnt vmcnt(0)
  v_max3_u32 v96, v88, v89, v90
  v_max3_u32 v96, v96, v91, v92
  v_max3_u32 v96, v96, v93, v94
  v_max_u32 v96, v96, v95
  v_cmp_eq_u32 vcc, -1, v96
  s_add_u32 s78, s78, 1
  s_cmp_gt_u32 s78, 0x200000
  s_cbranch_scc1 L_fpoll15x
  s_and_b64 exec, exec, vcc
  s_cbranch_execnz L_fpoll15
L_fpoll15x:
  s_mov_b64 exec, -1
  v_add_f32 v76, v88, v89
  v_add_f32 v77, v90, v91
  v_add_f32 v78, v92, v93
  v_add_f32 v79, v94, v95
  v_add_f32 v76, v76, v77
  v_add_f32 v78, v78, v79
  v_add_f32 v76, v76, v78
  s_mov_b32 s70, 0
  s_mov_b32 s71, -1
  v_add_f32_dpp v76, v76, v76 row_ror:8 row_mask:0xf bank_mask:0xf
  v_cndmask_b32 v80, v15, v0, s[70:71]
  v_mov_b32 v77, v76
  s_nop 1
  v_permlane16_swap_b32 v76, v77
  s_nop 1
  v_add_f32 v76, v76, v77
  v_cvt_pk_bf16_f32 v76, v76, v76
  v_and_b32 v76, 0xffff0000, v76
  v_mul_f32 v76, v80, v76
  v_cvt_pk_bf16_f32 v76, v76, v76
  v_and_b32 v76, 0xffff0000, v76
  v_mov_b32 v77, v76
  s_nop 1
  v_permlane32_swap_b32 v76, v77
  s_nop 1
  v_add_f32 v76, v76, v77
  v_cvt_pk_bf16_f32 v76, v76, v76
  s_lshl_b32 s65, s61, 10
  s_lshl_b32 s64, s64, 4
  s_add_u32 s64, s64, s65
  v_lshlrev_b32 v14, 1, v1
  v_add_u32 v14, s64, v14
  s_mov_b64 exec, 0xff
  global_store_short v14, v76, s[6:7]
L_end:
  s_endpgm
.section .rodata,"a"
.p2align 6
.amdhsa_kernel gated_mix__mha_block_cached__sliding_block_cached__decode_kernel
  .amdhsa_next_free_vgpr 252
  .amdhsa_next_free_sgpr 96
  .amdhsa_accum_offset 252
  .amdhsa_group_segment_fixed_size 0
  .amdhsa_kernarg_size 112
  .amdhsa_user_sgpr_count 2
  .amdhsa_user_sgpr_kernarg_segment_ptr 1
  .amdhsa_system_sgpr_workgroup_id_x 1
  .amdhsa_float_denorm_mode_32 3
.end_amdhsa_kernel
```
